```python
import torch

def _softmax(x, axis=-1):
    return torch.softmax(x, dim=axis)
def _gelu(x):
    return torch.nn.functional.gelu(x, approximate="tanh")
def _silu(x):
    return torch.nn.functional.silu(x)
def _sigmoid(x):
    return torch.sigmoid(x)
def _layernorm(x, axis=-1, eps=1e-5):
    m = x.mean(dim=axis, keepdim=True)
    v = x.var(dim=axis, keepdim=True, unbiased=False)
    return (x - m) / torch.sqrt(v + eps)
def _scatter_add(tgt, idx, src, axis=0):
    return tgt.clone().index_add_(axis, idx, src)
def _segment_sum(src, seg, n):
    out = torch.zeros((n,) + src.shape[1:], dtype=src.dtype)
    return out.index_add_(0, seg, src)
def _pad(x, pw):
    flat = tuple(v for pair in reversed(pw) for v in pair)
    return torch.nn.functional.pad(x, flat)

kernel_name = 'sequential_preLN__ssm_conv_h3__glu_gated_reglu__prompt'

def setup_inputs():

    _w = (lambda a: (lambda t: t.to(torch.bfloat16) if t.is_floating_point() else t)(torch.as_tensor(a)))
    def _A_setup():
        B, S, D = 1, 2048, 512
        ks = 4
        return {
            "q": _w((lambda *s: torch.randn(*s, dtype=torch.bfloat16) * 0.05)(B, S, D)),
            "k": _w((lambda *s: torch.randn(*s, dtype=torch.bfloat16) * 0.2)(B, S, D)),
            "v": _w((lambda *s: torch.randn(*s, dtype=torch.bfloat16) * 0.2)(B, S, D)),
            "shift_k": _w((lambda *s: torch.randn(*s, dtype=torch.bfloat16) * 0.2)(D, ks) * 0.5),
            "ssm_k": _w((lambda *s: torch.randn(*s, dtype=torch.bfloat16) * 0.4)(D, S) * (1.0 / S ** 0.5)),
            "ssm_D": _w((lambda *s: torch.randn(*s, dtype=torch.bfloat16) * 0.2)(D)),
        }
    _A_in = _A_setup()

    def _B_setup():
        B, S, D, F = 1, 2048, 512, 1376
        return {
            "x": _w((lambda *s: torch.randn(*s, dtype=torch.bfloat16) * 0.05)(B, S, D)),
            "W_gate": _w((lambda *s: torch.randn(*s, dtype=torch.bfloat16) * 0.2)(D, F) * (2.0 / D) ** 0.5),
            "W_up": _w((lambda *s: torch.randn(*s, dtype=torch.bfloat16) * 0.2)(D, F) * (2.0 / D) ** 0.5),
            "W_down": _w((lambda *s: torch.randn(*s, dtype=torch.bfloat16) * 0.2)(F, D) * (1.0 / F) ** 0.5),
        }
    _B_in = _B_setup()

    return {
        "A_q": _A_in["q"],
        "A_k": _A_in["k"],
        "A_v": _A_in["v"],
        "A_shift_k": _A_in["shift_k"],
        "A_ssm_k": _A_in["ssm_k"],
        "A_ssm_D": _A_in["ssm_D"],
        "B_x": _B_in["x"],
        "B_W_gate": _B_in["W_gate"],
        "B_W_up": _B_in["W_up"],
        "B_W_down": _B_in["W_down"],
    }

def reference(A_q, A_k, A_v, A_shift_k, A_ssm_k, A_ssm_D, B_x, B_W_gate, B_W_up, B_W_down):
    def _A_ref(q, k, v, shift_k, ssm_k, ssm_D):
        B, S, D = q.shape
        ks = shift_k.shape[-1]
        k_pad = _pad(k, ((0, 0), (ks - 1, 0), (0, 0)))
        k_shift = torch.zeros_like(k)
        for t in range(ks):
            k_shift = k_shift + k_pad[:, t:t + S, :] * shift_k[:, ks - 1 - t][None, None, :]
        kv = k_shift * v
        L = 2 * S
        kv_pad = _pad(kv, ((0, 0), (0, S), (0, 0)))
        kf_pad = _pad(ssm_k, ((0, 0), (0, S)))
        kv_f = (lambda x, axes=(-2,-1): torch.fft.rfft2(x.float(), dim=axes))(kv_pad[:, None, :, :], axes=(1, 2))
        kf_f = (lambda x, axes=(-2,-1): torch.fft.rfft2(x.float(), dim=axes))(kf_pad[:, None, :], axes=(1, 2))
        kf_f = (lambda x, *d: x.permute(*d))(kf_f, 1, 2, 0)
        y_f = kv_f * kf_f[None, :, :, :]
        y = (lambda x, s, axes=(-2,-1): torch.fft.irfft2(x, s=s, dim=axes).to(torch.bfloat16))(y_f, (1, L), axes=(1, 2))[:, 0, :S, :]
        y = y + kv * ssm_D[None, None, :]
        return q * y

    def _B_ref(x, W_gate, W_up, W_down):
        gate = torch.einsum("bsd,df->bsf", x, W_gate)
        up = torch.einsum("bsd,df->bsf", x, W_up)
        gate = gate * (lambda x, dt: x.to(dt))(gate > 0, gate.dtype)
        h = gate * up
        return torch.einsum("bsf,fd->bsd", h, W_down)

    x = A_q
    h = x + _A_ref(_layernorm(x, axis=-1), A_k, A_v, A_shift_k, A_ssm_k, A_ssm_D)
    h2 = h + _B_ref(_layernorm(h, axis=-1), B_W_gate, B_W_up, B_W_down)
    return h2
```

```asm
; @launch grid=(256,1,1) block=(512,1,1) lds=163840
.amdgcn_target "amdgcn-amd-amdhsa--gfx950"
.text
.globl sequential_preLN__ssm_conv_h3__glu_gated_reglu__prompt_kernel
.p2align 8
.type sequential_preLN__ssm_conv_h3__glu_gated_reglu__prompt_kernel,@function
sequential_preLN__ssm_conv_h3__glu_gated_reglu__prompt_kernel:
    s_cmp_ge_u32 s2, 256
    s_cbranch_scc1 L_end
    s_load_dwordx16 s[4:19], s[0:1], 0
    s_load_dwordx8 s[20:27], s[0:1], 64
    s_load_dwordx2 s[28:29], s[0:1], 96
    v_lshrrev_b32 v1, 6, v0
    v_and_b32 v2, 63, v0
    v_readfirstlane_b32 s3, v1
    s_getpc_b64 s[76:77]
L_pc:
    s_and_b32 s30, s2, 0xf8
    s_add_u32 s30, s30, s3
    s_lshl_b32 s30, s30, 7
    s_min_u32 s30, s30, L_end - L_pc
    v_mov_b32 v250, s30
    s_mov_b64 exec, 1
    global_load_dword v250, v250, s[76:77]
    s_mov_b64 exec, -1
    v_and_b32 v3, 255, v0
    v_and_b32 v10, 15, v3
    v_lshrrev_b32 v11, 4, v3
    s_bfe_u32 s30, s2, 0x30003
    s_lshr_b32 s31, s2, 6
    s_lshl_b32 s31, s31, 3
    s_and_b32 s76, s2, 7
    s_add_u32 s31, s31, s76
    s_lshl_b32 s76, s31, 16
    s_lshl_b32 s77, s30, 7
    s_add_u32 s76, s76, s77
    v_lshlrev_b32 v12, 12, v11
    v_lshl_add_u32 v12, v10, 3, v12
    v_add_u32 v12, s76, v12
    v_subrev_u32 v14, 3072, v12
    s_lshl_b32 s77, s30, 9
    v_lshlrev_b32 v15, 5, v10
    v_add_u32 v15, s77, v15
    s_lshl_b32 s77, s30, 5
    s_add_u32 s77, s77, s31
    s_lshl_b32 s77, s77, 7
    v_mov_b32 v253, s77
    v_mov_b32 v255, 0x428000
    s_cmp_ge_u32 s3, 4
    s_waitcnt lgkmcnt(0)
    s_mov_b32 s36, s6
    s_mov_b32 s37, s7
    s_mov_b32 s38, 0x200000
    s_mov_b32 s39, 0x20000
    s_mov_b32 s48, s10
    s_mov_b32 s49, s11
    s_mov_b32 s50, 0x1000
    s_mov_b32 s51, 0x20000
    s_mov_b32 s44, s8
    s_mov_b32 s45, s9
    s_mov_b32 s46, 0x200000
    s_mov_b32 s47, 0x20000
    s_mov_b32 s32, s4
    s_mov_b32 s33, s5
    s_mov_b32 s34, 0x200000
    s_mov_b32 s35, 0x20000
    s_cbranch_scc1 L_skipkv
    buffer_load_dwordx4 v[48:51], v15, s[48:51], 0 offen
    buffer_load_dwordx4 v[52:55], v15, s[48:51], 0 offen offset:16
    buffer_load_dwordx2 v[16:17], v14, s[36:39], 0 offen offset:0 nt
    buffer_load_dwordx2 v[18:19], v14, s[36:39], 0 offen offset:1024 nt
    buffer_load_dwordx2 v[20:21], v14, s[36:39], 0 offen offset:2048 nt
    buffer_load_dwordx2 v[22:23], v12, s[36:39], 0 offen offset:0 nt
    buffer_load_dwordx2 v[24:25], v12, s[36:39], 0 offen offset:1024 nt
    buffer_load_dwordx2 v[26:27], v12, s[36:39], 0 offen offset:2048 nt
    buffer_load_dwordx2 v[28:29], v12, s[36:39], 0 offen offset:3072 nt
    buffer_load_dwordx2 v[30:31], v12, s[44:47], 0 offen offset:0 nt
    buffer_load_dwordx2 v[32:33], v12, s[44:47], 0 offen offset:1024 nt
    buffer_load_dwordx2 v[34:35], v12, s[44:47], 0 offen offset:2048 nt
    buffer_load_dwordx2 v[36:37], v12, s[44:47], 0 offen offset:3072 nt
    s_branch L_kvdone
L_skipkv:
    buffer_load_dwordx2 v[38:39], v12, s[32:35], 0 offen offset:0 nt
    buffer_load_dwordx2 v[40:41], v12, s[32:35], 0 offen offset:1024 nt
    buffer_load_dwordx2 v[42:43], v12, s[32:35], 0 offen offset:2048 nt
    buffer_load_dwordx2 v[44:45], v12, s[32:35], 0 offen offset:3072 nt
L_kvdone:
    s_mov_b32 s40, s28
    s_mov_b32 s41, s29
    s_mov_b32 s42, 0xd50000
    s_mov_b32 s43, 0x20000
    buffer_load_dword v254, v255, s[40:43], 0 offen sc1
    s_mov_b32 s52, s12
    s_mov_b32 s53, s13
    s_mov_b32 s54, 0x200000
    s_mov_b32 s55, 0x20000
    s_mov_b32 s56, s14
    s_mov_b32 s57, s15
    s_mov_b32 s58, 0x400
    s_mov_b32 s59, 0x20000
    s_mov_b32 s60, s18
    s_mov_b32 s61, s19
    s_mov_b32 s62, 0x158000
    s_mov_b32 s63, 0x20000
    s_mov_b32 s64, s20
    s_mov_b32 s65, s21
    s_mov_b32 s66, 0x158000
    s_mov_b32 s67, 0x20000
    s_mov_b32 s68, s22
    s_mov_b32 s69, s23
    s_mov_b32 s70, 0x158000
    s_mov_b32 s71, 0x20000
    s_mov_b32 s72, s24
    s_mov_b32 s73, s25
    s_mov_b32 s74, 0x200000
    s_mov_b32 s75, 0x20000
    s_and_b32 s4, s2, 7
    s_lshr_b32 s5, s2, 3
    s_and_b32 s10, s4, 1
    s_lshr_b32 s17, s4, 1
    s_mul_i32 s7, s17, 3
    s_lshr_b32 s16, s5, 3
    s_add_u32 s7, s7, s16
    s_and_b32 s8, s5, 7
    s_lshr_b32 s15, s17, 1
    s_add_u32 s15, s15, 12
    s_and_b32 s16, s17, 1
    s_lshl_b32 s16, s16, 2
    s_and_b32 s6, s5, 3
    s_add_u32 s16, s16, s6
    s_cmp_ge_u32 s5, 24
    s_cselect_b32 s7, s15, s7
    s_cselect_b32 s8, s16, s8
    s_lshr_b32 s15, s5, 1
    s_lshl_b32 s16, s17, 1
    s_and_b32 s6, s5, 1
    s_add_u32 s16, s16, s6
    s_cmp_ge_u32 s5, 28
    s_cselect_b32 s7, s15, s7
    s_cselect_b32 s8, s16, s8
    s_lshl_b32 s6, s10, 3
    s_add_u32 s6, s6, s8
    s_and_b32 s11, s3, 3
    s_lshl_b32 s12, s4, 6
    s_lshl_b32 s13, s5, 1
    s_add_u32 s12, s12, s13
    s_lshr_b32 s77, s4, 1
    s_lshl_b32 s77, s77, 3
    s_lshr_b32 s16, s5, 2
    s_add_u32 s77, s77, s16
    s_lshr_b32 s13, s77, 1
    s_lshr_b32 s17, s3, 2
    s_lshl_b32 s17, s17, 13
    s_add_u32 s17, s17, 98560
    v_lshrrev_b32 v13, 1, v11
    v_and_b32 v14, 7, v10
    v_xor_b32 v13, v13, v14
    v_lshlrev_b32 v13, 4, v13
    v_lshl_add_u32 v13, v10, 9, v13
    v_and_b32 v14, 1, v11
    v_lshl_add_u32 v13, v14, 3, v13
    v_add_u32 v13, s17, v13
    v_lshrrev_b32 v128, 3, v2
    s_lshl_b32 s15, s11, 4
    v_add_u32 v128, s15, v128
    v_and_b32 v129, 7, v2
    v_lshrrev_b32 v130, 2, v128
    v_and_b32 v130, 7, v130
    v_xor_b32 v124, v129, v130
    v_xor_b32 v125, 2, v124
    v_lshlrev_b32 v130, 7, v128
    v_lshl_add_u32 v124, v124, 4, v130
    v_lshl_add_u32 v125, v125, 4, v130
    v_add_u32 v124, s17, v124
    v_add_u32 v125, s17, v125
    v_mul_u32_u24 v126, 4224, v128
    v_lshl_add_u32 v126, v129, 4, v126
    s_mul_i32 s18, s30, 270336
    s_lshl_b32 s16, s31, 7
    s_add_u32 s18, s18, s16
    s_lshr_b32 s16, s3, 2
    s_mul_i32 s16, s16, 0x210000
    s_add_u32 s18, s18, s16
    s_add_u32 s19, s18, 33792
    s_mov_b32 s14, 0xffff0000
    s_lshr_b32 s20, s11, 1
    s_and_b32 s21, s11, 1
    s_and_b32 s28, s4, 1
    s_lshl_b32 s28, s28, 2
    s_and_b32 s16, s5, 3
    s_add_u32 s28, s28, s16
    s_lshr_b32 s16, s5, 2
    s_mul_i32 s29, s16, 11
    s_lshr_b32 s29, s29, 3
    s_cmp_ge_u32 s3, 4
    s_cbranch_scc1 L_H
    v_lshlrev_b32 v6, 4, v3
    v_sub_u32 v7, 4080, v6
    v_subrev_u32 v8, 8, v7
    v_max_i32 v8, 0, v8
    s_add_u32 s22, s12, s20
    s_lshl_b32 s15, s22, 1
    v_mov_b32 v9, s15
    v_mov_b32 v240, 0
    s_lshl_b32 s15, s12, 12
    s_add_u32 s16, s15, 4096
    s_waitcnt vmcnt(12)
    v_lshlrev_b32 v92, 16, v48
    v_and_b32 v96, s14, v48
    v_lshlrev_b32 v100, 16, v49
    v_and_b32 v104, s14, v49
    v_lshlrev_b32 v93, 16, v50
    v_and_b32 v97, s14, v50
    v_lshlrev_b32 v101, 16, v51
    v_and_b32 v105, s14, v51
    v_lshlrev_b32 v94, 16, v52
    v_and_b32 v98, s14, v52
    v_lshlrev_b32 v102, 16, v53
    v_and_b32 v106, s14, v53
    v_lshlrev_b32 v95, 16, v54
    v_and_b32 v99, s14, v54
    v_lshlrev_b32 v103, 16, v55
    v_and_b32 v107, s14, v55
    s_waitcnt vmcnt(5)
    v_lshlrev_b32 v64, 16, v16
    v_and_b32 v65, s14, v16
    v_lshlrev_b32 v66, 16, v17
    v_and_b32 v67, s14, v17
    v_lshlrev_b32 v68, 16, v18
    v_and_b32 v69, s14, v18
    v_lshlrev_b32 v70, 16, v19
    v_and_b32 v71, s14, v19
    v_lshlrev_b32 v72, 16, v20
    v_and_b32 v73, s14, v20
    v_lshlrev_b32 v74, 16, v21
    v_and_b32 v75, s14, v21
    v_lshlrev_b32 v76, 16, v22
    v_and_b32 v77, s14, v22
    v_lshlrev_b32 v78, 16, v23
    v_and_b32 v79, s14, v23
    v_lshlrev_b32 v80, 16, v24
    v_and_b32 v81, s14, v24
    v_lshlrev_b32 v82, 16, v25
    v_and_b32 v83, s14, v25
    v_lshlrev_b32 v84, 16, v26
    v_and_b32 v85, s14, v26
    v_lshlrev_b32 v86, 16, v27
    v_and_b32 v87, s14, v27
    v_lshlrev_b32 v88, 16, v28
    v_and_b32 v89, s14, v28
    v_lshlrev_b32 v90, 16, v29
    v_and_b32 v91, s14, v29
    v_pk_mul_f32 v[108:109], v[64:65], v[104:105]
    v_pk_mul_f32 v[110:111], v[66:67], v[106:107]
    v_pk_mul_f32 v[112:113], v[68:69], v[104:105]
    v_pk_mul_f32 v[114:115], v[70:71], v[106:107]
    v_pk_mul_f32 v[116:117], v[72:73], v[104:105]
    v_pk_mul_f32 v[118:119], v[74:75], v[106:107]
    v_pk_mul_f32 v[120:121], v[76:77], v[104:105]
    v_pk_mul_f32 v[122:123], v[78:79], v[106:107]
    v_pk_fma_f32 v[108:109], v[68:69], v[100:101], v[108:109]
    v_pk_fma_f32 v[110:111], v[70:71], v[102:103], v[110:111]
    v_pk_fma_f32 v[112:113], v[72:73], v[100:101], v[112:113]
    v_pk_fma_f32 v[114:115], v[74:75], v[102:103], v[114:115]
    v_pk_fma_f32 v[116:117], v[76:77], v[100:101], v[116:117]
    v_pk_fma_f32 v[118:119], v[78:79], v[102:103], v[118:119]
    v_pk_fma_f32 v[120:121], v[80:81], v[100:101], v[120:121]
    v_pk_fma_f32 v[122:123], v[82:83], v[102:103], v[122:123]
    v_pk_fma_f32 v[108:109], v[72:73], v[96:97], v[108:109]
    v_pk_fma_f32 v[110:111], v[74:75], v[98:99], v[110:111]
    v_pk_fma_f32 v[112:113], v[76:77], v[96:97], v[112:113]
    v_pk_fma_f32 v[114:115], v[78:79], v[98:99], v[114:115]
    v_pk_fma_f32 v[116:117], v[80:81], v[96:97], v[116:117]
    v_pk_fma_f32 v[118:119], v[82:83], v[98:99], v[118:119]
    v_pk_fma_f32 v[120:121], v[84:85], v[96:97], v[120:121]
    v_pk_fma_f32 v[122:123], v[86:87], v[98:99], v[122:123]
    v_pk_fma_f32 v[108:109], v[76:77], v[92:93], v[108:109]
    v_pk_fma_f32 v[110:111], v[78:79], v[94:95], v[110:111]
    v_pk_fma_f32 v[112:113], v[80:81], v[92:93], v[112:113]
    v_pk_fma_f32 v[114:115], v[82:83], v[94:95], v[114:115]
    v_pk_fma_f32 v[116:117], v[84:85], v[92:93], v[116:117]
    v_pk_fma_f32 v[118:119], v[86:87], v[94:95], v[118:119]
    v_pk_fma_f32 v[120:121], v[88:89], v[92:93], v[120:121]
    v_pk_fma_f32 v[122:123], v[90:91], v[94:95], v[122:123]
    s_waitcnt vmcnt(1)
    v_lshlrev_b32 v64, 16, v30
    v_and_b32 v65, s14, v30
    v_lshlrev_b32 v66, 16, v31
    v_and_b32 v67, s14, v31
    v_lshlrev_b32 v68, 16, v32
    v_and_b32 v69, s14, v32
    v_lshlrev_b32 v70, 16, v33
    v_and_b32 v71, s14, v33
    v_lshlrev_b32 v72, 16, v34
    v_and_b32 v73, s14, v34
    v_lshlrev_b32 v74, 16, v35
    v_and_b32 v75, s14, v35
    v_lshlrev_b32 v76, 16, v36
    v_and_b32 v77, s14, v36
    v_lshlrev_b32 v78, 16, v37
    v_and_b32 v79, s14, v37
    v_pk_mul_f32 v[108:109], v[108:109], v[64:65]
    v_pk_mul_f32 v[110:111], v[110:111], v[66:67]
    v_pk_mul_f32 v[112:113], v[112:113], v[68:69]
    v_pk_mul_f32 v[114:115], v[114:115], v[70:71]
    v_pk_mul_f32 v[116:117], v[116:117], v[72:73]
    v_pk_mul_f32 v[118:119], v[118:119], v[74:75]
    v_pk_mul_f32 v[120:121], v[120:121], v[76:77]
    v_pk_mul_f32 v[122:123], v[122:123], v[78:79]
    v_cvt_pk_bf16_f32 v80, v108, v112
    v_cvt_pk_bf16_f32 v81, v116, v120
    ds_write_b64 v13, v[80:81] offset:0
    v_cvt_pk_bf16_f32 v82, v109, v113
    v_cvt_pk_bf16_f32 v83, v117, v121
    ds_write_b64 v13, v[82:83] offset:128
    v_cvt_pk_bf16_f32 v84, v110, v114
    v_cvt_pk_bf16_f32 v85, v118, v122
    ds_write_b64 v13, v[84:85] offset:256
    v_cvt_pk_bf16_f32 v86, v111, v115
    v_cvt_pk_bf16_f32 v87, v119, v123
    ds_write_b64 v13, v[86:87] offset:384
    s_and_b32 s15, s2, 0xc7
    s_or_b32 s15, s15, s11
    s_cmp_lg_u32 s15, 0
    s_cbranch_scc1 L_noinit
    s_waitcnt vmcnt(0)
    v_add_u32 v132, 1, v254
    v_lshlrev_b32 v132, 6, v132
    v_lshrrev_b32 v133, 0, v2
    v_lshlrev_b32 v133, 10, v133
    v_and_b32 v134, 0, v2
    v_lshl_add_u32 v133, v134, 7, v133
    s_lshl_b32 s15, s2, 4
    s_add_u32 s15, s15, 0x4d0000
    s_mov_b32 exec_lo, 0xffff
    s_mov_b32 exec_hi, 0x0
    buffer_store_dword v132, v133, s[40:43], s15 offen sc1
    s_mov_b64 exec, -1
L_noinit:
    s_cmp_ge_u32 s2, 32
    s_cbranch_scc1 L_noinit3
    s_cmp_lg_u32 s11, 1
    s_cbranch_scc1 L_noinit3
    s_waitcnt vmcnt(0)
    v_add_u32 v132, 1, v254
    v_lshlrev_b32 v132, 6, v132
    s_lshl_b32 s15, s2, 9
    s_add_u32 s15, s15, 0x440000
    v_lshlrev_b32 v133, 7, v2
    s_mov_b64 exec, 7
    buffer_store_dword v132, v133, s[40:43], s15 offen sc1
    s_mov_b64 exec, -1
L_noinit3:
    s_waitcnt lgkmcnt(0)
    s_barrier
    ds_read_b128 v[28:31], v124
    ds_read_b128 v[32:35], v125 offset:1024
    s_waitcnt lgkmcnt(1)
    buffer_store_dwordx4 v[28:31], v126, s[40:43], s18 offen sc1
    s_waitcnt lgkmcnt(0)
    buffer_store_dwordx4 v[32:35], v126, s[40:43], s19 offen sc1
    v_mov_b32 v72, 0
    v_mov_b32 v73, 0
    v_mov_b32 v74, 0
    v_mov_b32 v75, 0
    v_lshrrev_b32 v17, 5, v3
    v_mul_u32_u24 v17, 21248, v17
    v_and_b32 v18, 31, v3
    v_lshl_add_u32 v17, v18, 4, v17
    v_add_u32 v17, 115200, v17
    v_bfe_u32 v18, v3, 4, 1
    v_mul_u32_u24 v18, 21248, v18
    v_bfe_u32 v19, v3, 2, 2
    v_mul_u32_u24 v19, 4160, v19
    v_add_u32 v18, v18, v19
    v_and_b32 v19, 3, v3
    v_lshl_add_u32 v18, v19, 4, v18
    v_add_u32 v18, 102656, v18
    s_lshl_b32 s16, s4, 5
    s_lshl_b32 s17, s21, 4
    s_add_u32 s16, s16, s17
    v_and_b32 v20, 15, v2
    v_add_u32 v20, s16, v20
    v_lshlrev_b32 v20, 7, v20
    v_add_u32 v20, 0x430000, v20
    s_mul_i32 s24, s22, 4224
    s_lshl_b32 s25, s21, 11
    s_add_u32 s24, s24, s25
    s_mul_i32 s23, s20, 21248
    s_add_u32 s23, s23, 98560
    s_add_u32 s26, s23, 17152
    s_add_u32 s26, s26, s25
    v_lshlrev_b32 v5, 4, v2
    s_lshl_b32 s15, s12, 12
    s_add_u32 s16, s15, 4096
    buffer_load_dwordx4 v[228:231], v7, s[52:55], s15 offen nt
    buffer_load_dwordx2 v[226:227], v8, s[52:55], s15 offen nt
    buffer_load_dwordx4 v[236:239], v7, s[52:55], s16 offen nt
    buffer_load_dwordx2 v[234:235], v8, s[52:55], s16 offen nt
    buffer_load_short_d16_hi v240, v9, s[56:59], 0 offen
    s_waitcnt vmcnt(5)
    s_barrier
    s_mov_b32 s15, 0xffff
    v_cmp_ne_u32 vcc, 255, v3
    v_add_u32 v16, 98560, v6
    s_waitcnt vmcnt(0)
    v_add_u32 v254, 1, v254
    v_cndmask_b32 v226, 0, v226, vcc
    v_cndmask_b32 v227, 0, v227, vcc
    v_bfi_b32 v40, s15, v230, v229
    v_bfi_b32 v41, s15, v229, v228
    v_bfi_b32 v42, s15, v228, v227
    v_bfi_b32 v43, s15, v227, v226
    v_alignbit_b32 v44, v230, v230, 16
    v_alignbit_b32 v45, v229, v229, 16
    v_alignbit_b32 v46, v228, v228, 16
    v_alignbit_b32 v47, v227, v227, 16
    v_bfi_b32 v48, s15, v231, v230
    v_bfi_b32 v49, s15, v230, v229
    v_bfi_b32 v50, s15, v229, v228
    v_bfi_b32 v51, s15, v228, v227
    v_alignbit_b32 v52, v231, v231, 16
    v_alignbit_b32 v53, v230, v230, 16
    v_alignbit_b32 v54, v229, v229, 16
    v_alignbit_b32 v55, v228, v228, 16
    v_cndmask_b32 v234, 0, v234, vcc
    v_cndmask_b32 v235, 0, v235, vcc
    v_bfi_b32 v56, s15, v238, v237
    v_bfi_b32 v57, s15, v237, v236
    v_bfi_b32 v58, s15, v236, v235
    v_bfi_b32 v59, s15, v235, v234
    v_alignbit_b32 v60, v238, v238, 16
    v_alignbit_b32 v61, v237, v237, 16
    v_alignbit_b32 v62, v236, v236, 16
    v_alignbit_b32 v63, v235, v235, 16
    v_bfi_b32 v64, s15, v239, v238
    v_bfi_b32 v65, s15, v238, v237
    v_bfi_b32 v66, s15, v237, v236
    v_bfi_b32 v67, s15, v236, v235
    v_alignbit_b32 v68, v239, v239, 16
    v_alignbit_b32 v69, v238, v238, 16
    v_alignbit_b32 v70, v237, v237, 16
    v_alignbit_b32 v71, v236, v236, 16
    v_readfirstlane_b32 s9, v254
    ds_write_b128 v16, v[40:43] offset:0
    ds_write_b128 v16, v[44:47] offset:4160
    ds_write_b128 v16, v[48:51] offset:8320
    ds_write_b128 v16, v[52:55] offset:12480
    ds_write_b128 v16, v[56:59] offset:21248
    ds_write_b128 v16, v[60:63] offset:25408
    ds_write_b128 v16, v[64:67] offset:29568
    ds_write_b128 v16, v[68:71] offset:33728
    s_cmp_lg_u32 s11, 0
    s_cbranch_scc1 L_nopad
    ds_write_b128 v17, v[72:75]
    s_mov_b32 exec_hi, 0
    ds_write_b128 v18, v[72:75]
L_nopad:
    s_mov_b64 exec, -1
    s_waitcnt lgkmcnt(0)
    s_barrier
    s_mov_b32 m0, s26
    s_nop 0
    buffer_load_dwordx4 v5, s[40:43], s24 offen sc1 lds
    buffer_load_dwordx4 v5, s[40:43], s24 offen offset:1024 sc1 lds
    s_sub_u32 s24, s24, s25
    s_xor_b32 s31, s21, 1
    s_lshl_b32 s15, s31, 11
    s_add_u32 s24, s24, s15
    s_lshl_b32 s15, s11, 11
    s_add_u32 m0, s15, 90304
    s_add_u32 s24, s24, 0x210000
    buffer_load_dwordx4 v5, s[40:43], s24 offen sc1 lds
    buffer_load_dwordx4 v5, s[40:43], s24 offen offset:1024 sc1 lds
    v_and_b32 v6, 15, v2
    v_lshrrev_b32 v7, 4, v2
    v_lshlrev_b32 v8, 4, v6
    v_lshl_add_u32 v8, v7, 2, v8
    v_and_b32 v32, 3, v6
    v_mul_u32_u24 v32, 4160, v32
    v_lshrrev_b32 v33, 2, v6
    v_lshlrev_b32 v33, 3, v33
    v_lshl_add_u32 v33, v7, 4, v33
    v_sub_u32 v32, v32, v33
    s_lshl_b32 s15, s21, 8
    s_sub_u32 s16, s23, s15
    s_add_u32 s17, s16, 328
    v_add_u32 v32, s17, v32
    v_lshlrev_b32 v33, 5, v6
    v_lshlrev_b32 v34, 4, v7
    v_sub_u32 v33, v33, v34
    s_add_u32 s17, s16, 16976
    v_add_u32 v33, s17, v33
    v_lshlrev_b32 v9, 1, v8
    s_lshl_b32 s15, s11, 12
    s_add_u32 s15, s15, 73920
    s_xor_b32 s16, s11, 1
    s_lshl_b32 s16, s16, 12
    s_add_u32 s16, s16, 73920
    v_add_u32 v34, s15, v5
    v_add_u32 v35, s16, v5
    v_add_u32 v12, s26, v9
    s_lshl_b32 s17, s11, 11
    s_add_u32 s17, s17, 90304
    v_add_u32 v10, s17, v9
    s_lshl_b32 s17, s31, 13
    s_add_u32 s17, s17, 141056
    v_add_u32 v13, s17, v5
    v_and_b32 v14, 7, v6
    v_lshlrev_b32 v14, 1, v14
    v_lshrrev_b32 v15, 1, v7
    v_add_u32 v14, v14, v15
    s_and_b32 s15, s22, 3
    s_lshl_b32 s15, s15, 2
    v_xor_b32 v14, s15, v14
    v_lshlrev_b32 v14, 4, v14
    v_lshrrev_b32 v15, 3, v6
    v_lshl_add_u32 v14, v15, 17, v14
    v_and_b32 v15, 1, v7
    v_lshl_add_u32 v14, v15, 18, v14
    s_lshl_b32 s18, s22, 8
    s_lshl_b32 s17, s31, 20
    s_add_u32 s18, s18, s17
    s_add_u32 s18, s18, 0x510000
    s_add_u32 s19, s18, 524288
    s_lshl_b32 s15, s11, 2
    s_add_u32 s15, s15, 163776
    v_mov_b32 v16, s15
    s_xor_b32 s15, s15, 4
    v_mov_b32 v17, s15
    v_mov_b32 v18, 163792
    v_mov_b32 v19, 1
    v_subrev_u32 v20, 8, v2
    v_and_b32 v21, 7, v2
    v_lshrrev_b32 v22, 16, v240
    v_and_b32 v23, 1, v21
    v_lshlrev_b32 v23, 4, v23
    v_lshlrev_b32 v22, v23, v22
    v_cmp_gt_u32 vcc, 16, v20
    v_lshrrev_b32 v21, 1, v21
    s_nop 0
    v_cndmask_b32 v22, 0, v22, vcc
    v_cmp_eq_u32 vcc, 0, v21
    s_nop 1
    v_cndmask_b32 v232, 0, v22, vcc
    v_cmp_eq_u32 vcc, 1, v21
    s_nop 1
    v_cndmask_b32 v233, 0, v22, vcc
    v_cmp_eq_u32 vcc, 2, v21
    s_nop 1
    v_cndmask_b32 v234, 0, v22, vcc
    v_cmp_eq_u32 vcc, 3, v21
    s_nop 1
    v_cndmask_b32 v235, 0, v22, vcc
    ds_read_b64 v[72:73], v32 offset:3776
    ds_read_b64 v[74:75], v32 offset:3784
    ds_read_b64 v[76:77], v32 offset:3264
    ds_read_b64 v[78:79], v32 offset:3272
    ds_read_b64 v[80:81], v32 offset:2752
    ds_read_b64 v[82:83], v32 offset:2760
    ds_read_b64 v[84:85], v32 offset:2240
    ds_read_b64 v[86:87], v32 offset:2248
    ds_read_b64 v[88:89], v32 offset:1728
    ds_read_b64 v[90:91], v32 offset:1736
    ds_read_b64 v[92:93], v32 offset:1216
    ds_read_b64 v[94:95], v32 offset:1224
    ds_read_b64 v[96:97], v32 offset:704
    ds_read_b64 v[98:99], v32 offset:712
    ds_read_b64 v[100:101], v32 offset:192
    ds_read_b64 v[102:103], v32 offset:200
    s_waitcnt vmcnt(2) lgkmcnt(0)
    s_barrier
    ds_read_b128 v[104:107], v33 offset:192
    ds_read_b128 v[108:111], v33 offset:704
    ds_read_b128 v[112:115], v33 offset:1216
    ds_read_b128 v[116:119], v33 offset:1728
    ds_read_b128 v[120:123], v33 offset:2240
    ds_read_b128 v[124:127], v33 offset:2752
    ds_read_b128 v[128:131], v33 offset:3264
    ds_read_b128 v[132:135], v33 offset:3776
    s_waitcnt lgkmcnt(7)
    v_mfma_f32_16x16x32_bf16 v[36:39], v[72:75], v[104:107], 0
    s_waitcnt lgkmcnt(6)
    v_mfma_f32_16x16x32_bf16 v[40:43], v[72:75], v[108:111], 0
    ds_read_b128 v[168:171], v33 offset:128
    v_mfma_f32_16x16x32_bf16 v[40:43], v[76:79], v[104:107], v[40:43]
    ds_read_b64 v[136:137], v32 offset:3712
    v_mfma_f32_16x16x32_bf16 v[44:47], v[76:79], v[108:111], 0
    ds_read_b64 v[138:139], v32 offset:3720
    s_waitcnt lgkmcnt(8)
    v_mfma_f32_16x16x32_bf16 v[44:47], v[72:75], v[112:115], v[44:47]
    v_mfma_f32_16x16x32_bf16 v[44:47], v[80:83], v[104:107], v[44:47]
    ds_read_b128 v[172:175], v33 offset:640
    v_mfma_f32_16x16x32_bf16 v[48:51], v[76:79], v[112:115], 0
    ds_read_b64 v[140:141], v32 offset:3200
    v_mfma_f32_16x16x32_bf16 v[48:51], v[80:83], v[108:111], v[48:51]
    ds_read_b64 v[142:143], v32 offset:3208
    v_mfma_f32_16x16x32_bf16 v[52:55], v[80:83], v[112:115], 0
    s_waitcnt lgkmcnt(10)
    v_mfma_f32_16x16x32_bf16 v[48:51], v[72:75], v[116:119], v[48:51]
    ds_read_b128 v[176:179], v33 offset:1152
    v_mfma_f32_16x16x32_bf16 v[48:51], v[84:87], v[104:107], v[48:51]
    ds_read_b64 v[144:145], v32 offset:2688
    v_mfma_f32_16x16x32_bf16 v[52:55], v[76:79], v[116:119], v[52:55]
    ds_read_b64 v[146:147], v32 offset:2696
    v_mfma_f32_16x16x32_bf16 v[52:55], v[84:87], v[108:111], v[52:55]
    v_mfma_f32_16x16x32_bf16 v[56:59], v[80:83], v[116:119], 0
    ds_read_b128 v[180:183], v33 offset:1664
    v_mfma_f32_16x16x32_bf16 v[56:59], v[84:87], v[112:115], v[56:59]
    ds_read_b64 v[148:149], v32 offset:2176
    v_mfma_f32_16x16x32_bf16 v[60:63], v[84:87], v[116:119], 0
    ds_read_b64 v[150:151], v32 offset:2184
    s_waitcnt lgkmcnt(14)
    v_mfma_f32_16x16x32_bf16 v[52:55], v[72:75], v[120:123], v[52:55]
    v_mfma_f32_16x16x32_bf16 v[52:55], v[88:91], v[104:107], v[52:55]
    ds_read_b128 v[184:187], v33 offset:2176
    v_mfma_f32_16x16x32_bf16 v[56:59], v[76:79], v[120:123], v[56:59]
    ds_read_b64 v[152:153], v32 offset:1664
    v_mfma_f32_16x16x32_bf16 v[56:59], v[88:91], v[108:111], v[56:59]
    ds_read_b64 v[154:155], v32 offset:1672
    v_mfma_f32_16x16x32_bf16 v[60:63], v[80:83], v[120:123], v[60:63]
    v_mfma_f32_16x16x32_bf16 v[60:63], v[88:91], v[112:115], v[60:63]
    ds_read_b128 v[188:191], v33 offset:2688
    v_mfma_f32_16x16x32_bf16 v[64:67], v[84:87], v[120:123], 0
    ds_read_b64 v[156:157], v32 offset:1152
    v_mfma_f32_16x16x32_bf16 v[64:67], v[88:91], v[116:119], v[64:67]
    ds_read_b64 v[158:159], v32 offset:1160
    v_mfma_f32_16x16x32_bf16 v[56:59], v[72:75], v[124:127], v[56:59]
    v_mfma_f32_16x16x32_bf16 v[56:59], v[92:95], v[104:107], v[56:59]
    ds_read_b128 v[192:195], v33 offset:3200
    v_mfma_f32_16x16x32_bf16 v[60:63], v[76:79], v[124:127], v[60:63]
    ds_read_b64 v[160:161], v32 offset:640
    v_mfma_f32_16x16x32_bf16 v[60:63], v[92:95], v[108:111], v[60:63]
    ds_read_b64 v[162:163], v32 offset:648
    v_mfma_f32_16x16x32_bf16 v[64:67], v[80:83], v[124:127], v[64:67]
    v_mfma_f32_16x16x32_bf16 v[64:67], v[92:95], v[112:115], v[64:67]
    ds_read_b128 v[196:199], v33 offset:3712
    s_waitcnt lgkmcnt(14)
    v_mfma_f32_16x16x32_bf16 v[60:63], v[72:75], v[128:131], v[60:63]
    ds_read_b64 v[164:165], v32 offset:128
    v_mfma_f32_16x16x32_bf16 v[60:63], v[96:99], v[104:107], v[60:63]
    ds_read_b64 v[166:167], v32 offset:136
    v_mfma_f32_16x16x32_bf16 v[64:67], v[76:79], v[128:131], v[64:67]
    v_mfma_f32_16x16x32_bf16 v[64:67], v[96:99], v[108:111], v[64:67]
    v_mfma_f32_16x16x32_bf16 v[64:67], v[72:75], v[132:135], v[64:67]
    v_mfma_f32_16x16x32_bf16 v[64:67], v[100:103], v[104:107], v[64:67]
    s_cmp_lg_u32 s21, 0
    s_cbranch_scc1 L_nodiag
    v_mfma_f32_16x16x32_bf16 v[36:39], v[232:235], v[104:107], v[36:39]
    v_mfma_f32_16x16x32_bf16 v[40:43], v[232:235], v[108:111], v[40:43]
    v_mfma_f32_16x16x32_bf16 v[44:47], v[232:235], v[112:115], v[44:47]
    v_mfma_f32_16x16x32_bf16 v[48:51], v[232:235], v[116:119], v[48:51]
    v_mfma_f32_16x16x32_bf16 v[52:55], v[232:235], v[120:123], v[52:55]
    v_mfma_f32_16x16x32_bf16 v[56:59], v[232:235], v[124:127], v[56:59]
    v_mfma_f32_16x16x32_bf16 v[60:63], v[232:235], v[128:131], v[60:63]
    v_mfma_f32_16x16x32_bf16 v[64:67], v[232:235], v[132:135], v[64:67]
L_nodiag:
    v_mfma_f32_16x16x32_bf16 v[36:39], v[136:139], v[168:171], v[36:39]
    v_mfma_f32_16x16x32_bf16 v[40:43], v[136:139], v[172:175], v[40:43]
    ds_read_b128 v[104:107], v33 offset:64
    v_mfma_f32_16x16x32_bf16 v[40:43], v[140:143], v[168:171], v[40:43]
    ds_read_b64 v[72:73], v32 offset:3648
    v_mfma_f32_16x16x32_bf16 v[44:47], v[140:143], v[172:175], v[44:47]
    ds_read_b64 v[74:75], v32 offset:3656
    v_mfma_f32_16x16x32_bf16 v[44:47], v[136:139], v[176:179], v[44:47]
    s_waitcnt lgkmcnt(14)
    v_mfma_f32_16x16x32_bf16 v[44:47], v[144:147], v[168:171], v[44:47]
    ds_read_b128 v[108:111], v33 offset:576
    v_mfma_f32_16x16x32_bf16 v[48:51], v[140:143], v[176:179], v[48:51]
    ds_read_b64 v[76:77], v32 offset:3136
    v_mfma_f32_16x16x32_bf16 v[48:51], v[144:147], v[172:175], v[48:51]
    ds_read_b64 v[78:79], v32 offset:3144
    v_mfma_f32_16x16x32_bf16 v[52:55], v[144:147], v[176:179], v[52:55]
    v_mfma_f32_16x16x32_bf16 v[48:51], v[136:139], v[180:183], v[48:51]
    ds_read_b128 v[112:115], v33 offset:1088
    v_mfma_f32_16x16x32_bf16 v[48:51], v[148:151], v[168:171], v[48:51]
    ds_read_b64 v[80:81], v32 offset:2624
    v_mfma_f32_16x16x32_bf16 v[52:55], v[140:143], v[180:183], v[52:55]
    ds_read_b64 v[82:83], v32 offset:2632
    v_mfma_f32_16x16x32_bf16 v[52:55], v[148:151], v[172:175], v[52:55]
    v_mfma_f32_16x16x32_bf16 v[56:59], v[144:147], v[180:183], v[56:59]
    ds_read_b128 v[116:119], v33 offset:1600
    v_mfma_f32_16x16x32_bf16 v[56:59], v[148:151], v[176:179], v[56:59]
    ds_read_b64 v[84:85], v32 offset:2112
    v_mfma_f32_16x16x32_bf16 v[60:63], v[148:151], v[180:183], v[60:63]
    ds_read_b64 v[86:87], v32 offset:2120
    v_mfma_f32_16x16x32_bf16 v[52:55], v[136:139], v[184:187], v[52:55]
    s_waitcnt lgkmcnt(14)
    v_mfma_f32_16x16x32_bf16 v[52:55], v[152:155], v[168:171], v[52:55]
    ds_read_b128 v[120:123], v33 offset:2112
    v_mfma_f32_16x16x32_bf16 v[56:59], v[140:143], v[184:187], v[56:59]
    ds_read_b64 v[88:89], v32 offset:1600
    v_mfma_f32_16x16x32_bf16 v[56:59], v[152:155], v[172:175], v[56:59]
    ds_read_b64 v[90:91], v32 offset:1608
    v_mfma_f32_16x16x32_bf16 v[60:63], v[144:147], v[184:187], v[60:63]
    v_mfma_f32_16x16x32_bf16 v[60:63], v[152:155], v[176:179], v[60:63]
    ds_read_b128 v[124:127], v33 offset:2624
    v_mfma_f32_16x16x32_bf16 v[64:67], v[148:151], v[184:187], v[64:67]
    ds_read_b64 v[92:93], v32 offset:1088
    v_mfma_f32_16x16x32_bf16 v[64:67], v[152:155], v[180:183], v[64:67]
    ds_read_b64 v[94:95], v32 offset:1096
    v_mfma_f32_16x16x32_bf16 v[56:59], v[136:139], v[188:191], v[56:59]
    v_mfma_f32_16x16x32_bf16 v[56:59], v[156:159], v[168:171], v[56:59]
    ds_read_b128 v[128:131], v33 offset:3136
    v_mfma_f32_16x16x32_bf16 v[60:63], v[140:143], v[188:191], v[60:63]
    ds_read_b64 v[96:97], v32 offset:576
    v_mfma_f32_16x16x32_bf16 v[60:63], v[156:159], v[172:175], v[60:63]
    ds_read_b64 v[98:99], v32 offset:584
    v_mfma_f32_16x16x32_bf16 v[64:67], v[144:147], v[188:191], v[64:67]
    v_mfma_f32_16x16x32_bf16 v[64:67], v[156:159], v[176:179], v[64:67]
    ds_read_b128 v[132:135], v33 offset:3648
    v_mfma_f32_16x16x32_bf16 v[60:63], v[136:139], v[192:195], v[60:63]
    ds_read_b64 v[100:101], v32 offset:64
    v_mfma_f32_16x16x32_bf16 v[60:63], v[160:163], v[168:171], v[60:63]
    ds_read_b64 v[102:103], v32 offset:72
    v_mfma_f32_16x16x32_bf16 v[64:67], v[140:143], v[192:195], v[64:67]
    v_mfma_f32_16x16x32_bf16 v[64:67], v[160:163], v[172:175], v[64:67]
    v_mfma_f32_16x16x32_bf16 v[64:67], v[136:139], v[196:199], v[64:67]
    s_waitcnt lgkmcnt(14)
    v_mfma_f32_16x16x32_bf16 v[64:67], v[164:167], v[168:171], v[64:67]
    v_mfma_f32_16x16x32_bf16 v[36:39], v[72:75], v[104:107], v[36:39]
    v_mfma_f32_16x16x32_bf16 v[40:43], v[72:75], v[108:111], v[40:43]
    ds_read_b128 v[168:171], v33 offset:0
    v_mfma_f32_16x16x32_bf16 v[40:43], v[76:79], v[104:107], v[40:43]
    ds_read_b64 v[136:137], v32 offset:3584
    v_mfma_f32_16x16x32_bf16 v[44:47], v[76:79], v[108:111], v[44:47]
    ds_read_b64 v[138:139], v32 offset:3592
    v_mfma_f32_16x16x32_bf16 v[44:47], v[72:75], v[112:115], v[44:47]
    v_mfma_f32_16x16x32_bf16 v[44:47], v[80:83], v[104:107], v[44:47]
    ds_read_b128 v[172:175], v33 offset:512
    v_mfma_f32_16x16x32_bf16 v[48:51], v[76:79], v[112:115], v[48:51]
    ds_read_b64 v[140:141], v32 offset:3072
    v_mfma_f32_16x16x32_bf16 v[48:51], v[80:83], v[108:111], v[48:51]
    ds_read_b64 v[142:143], v32 offset:3080
    v_mfma_f32_16x16x32_bf16 v[52:55], v[80:83], v[112:115], v[52:55]
    v_mfma_f32_16x16x32_bf16 v[48:51], v[72:75], v[116:119], v[48:51]
    ds_read_b128 v[176:179], v33 offset:1024
    s_waitcnt lgkmcnt(14)
    v_mfma_f32_16x16x32_bf16 v[48:51], v[84:87], v[104:107], v[48:51]
    ds_read_b64 v[144:145], v32 offset:2560
    v_mfma_f32_16x16x32_bf16 v[52:55], v[76:79], v[116:119], v[52:55]
    ds_read_b64 v[146:147], v32 offset:2568
    v_mfma_f32_16x16x32_bf16 v[52:55], v[84:87], v[108:111], v[52:55]
    v_mfma_f32_16x16x32_bf16 v[56:59], v[80:83], v[116:119], v[56:59]
    ds_read_b128 v[180:183], v33 offset:1536
    v_mfma_f32_16x16x32_bf16 v[56:59], v[84:87], v[112:115], v[56:59]
    ds_read_b64 v[148:149], v32 offset:2048
    v_mfma_f32_16x16x32_bf16 v[60:63], v[84:87], v[116:119], v[60:63]
    ds_read_b64 v[150:151], v32 offset:2056
    v_mfma_f32_16x16x32_bf16 v[52:55], v[72:75], v[120:123], v[52:55]
    v_mfma_f32_16x16x32_bf16 v[52:55], v[88:91], v[104:107], v[52:55]
    ds_read_b128 v[184:187], v33 offset:2048
    v_mfma_f32_16x16x32_bf16 v[56:59], v[76:79], v[120:123], v[56:59]
    ds_read_b64 v[152:153], v32 offset:1536
    v_mfma_f32_16x16x32_bf16 v[56:59], v[88:91], v[108:111], v[56:59]
    ds_read_b64 v[154:155], v32 offset:1544
    v_mfma_f32_16x16x32_bf16 v[60:63], v[80:83], v[120:123], v[60:63]
    v_mfma_f32_16x16x32_bf16 v[60:63], v[88:91], v[112:115], v[60:63]
    ds_read_b128 v[188:191], v33 offset:2560
    v_mfma_f32_16x16x32_bf16 v[64:67], v[84:87], v[120:123], v[64:67]
    ds_read_b64 v[156:157], v32 offset:1024
    v_mfma_f32_16x16x32_bf16 v[64:67], v[88:91], v[116:119], v[64:67]
    ds_read_b64 v[158:159], v32 offset:1032
    v_mfma_f32_16x16x32_bf16 v[56:59], v[72:75], v[124:127], v[56:59]
    s_waitcnt lgkmcnt(14)
    v_mfma_f32_16x16x32_bf16 v[56:59], v[92:95], v[104:107], v[56:59]
    ds_read_b128 v[192:195], v33 offset:3072
    v_mfma_f32_16x16x32_bf16 v[60:63], v[76:79], v[124:127], v[60:63]
    ds_read_b64 v[160:161], v32 offset:512
    ds_read_b128 v[20:23], v18
    v_mfma_f32_16x16x32_bf16 v[60:63], v[92:95], v[108:111], v[60:63]
    ds_read_b64 v[162:163], v32 offset:520
    v_mfma_f32_16x16x32_bf16 v[64:67], v[80:83], v[124:127], v[64:67]
    v_mfma_f32_16x16x32_bf16 v[64:67], v[92:95], v[112:115], v[64:67]
    ds_read_b128 v[196:199], v33 offset:3584
    v_mfma_f32_16x16x32_bf16 v[60:63], v[72:75], v[128:131], v[60:63]
    ds_read_b64 v[164:165], v32 offset:0
    v_mfma_f32_16x16x32_bf16 v[60:63], v[96:99], v[104:107], v[60:63]
    ds_read_b64 v[166:167], v32 offset:8
    v_mfma_f32_16x16x32_bf16 v[64:67], v[76:79], v[128:131], v[64:67]
    s_waitcnt lgkmcnt(4)
    v_and_b32 v20, v20, v21
    v_mfma_f32_16x16x32_bf16 v[64:67], v[96:99], v[108:111], v[64:67]
    v_and_b32 v22, v22, v23
    v_mfma_f32_16x16x32_bf16 v[64:67], v[72:75], v[132:135], v[64:67]
    v_and_b32 v20, v20, v22
    v_mfma_f32_16x16x32_bf16 v[64:67], v[100:103], v[104:107], v[64:67]
    v_cmp_ne_u32 vcc, 1, v20
    s_cbranch_vccz L_auxok
L_aux:
    ds_read_b128 v[20:23], v18
    s_waitcnt lgkmcnt(0)
    v_and_b32 v20, v20, v21
    v_and_b32 v22, v22, v23
    v_and_b32 v20, v20, v22
    v_cmp_ne_u32 vcc, 1, v20
    s_cbranch_vccnz L_aux
L_auxok:
    s_waitcnt vmcnt(0) lgkmcnt(0)
    s_cmp_eq_u32 s21, 0
    s_cbranch_scc1 L_conv_h0
    v_mfma_f32_16x16x32_bf16 v[64:67], v[148:151], v[184:187], v[64:67]
    ds_read_b64 v[80:81], v10 offset:0
    ds_read_b128 v[88:91], v13 offset:0
    v_mfma_f32_16x16x32_bf16 v[60:63], v[148:151], v[180:183], v[60:63]
    ds_read_b128 v[92:95], v13 offset:1024
    ds_read_b64 v[82:83], v10 offset:512
    v_mfma_f32_16x16x32_bf16 v[64:67], v[152:155], v[180:183], v[64:67]
    ds_read_b128 v[96:99], v13 offset:2048
    ds_read_b128 v[100:103], v13 offset:3072
    v_mfma_f32_16x16x32_bf16 v[60:63], v[144:147], v[184:187], v[60:63]
    ds_read_b64 v[84:85], v10 offset:1024
    ds_read_b128 v[104:107], v13 offset:4096
    v_mfma_f32_16x16x32_bf16 v[64:67], v[144:147], v[188:191], v[64:67]
    ds_read_b128 v[108:111], v13 offset:5120
    ds_read_b64 v[86:87], v10 offset:1536
    v_mfma_f32_16x16x32_bf16 v[56:59], v[144:147], v[180:183], v[56:59]
    ds_read_b128 v[112:115], v13 offset:6144
    ds_read_b128 v[116:119], v13 offset:7168
    v_mfma_f32_16x16x32_bf16 v[64:67], v[156:159], v[176:179], v[64:67]
    s_waitcnt lgkmcnt(9)
    v_lshlrev_b32 v216, 16, v80
    v_mfma_f32_16x16x32_bf16 v[56:59], v[148:151], v[176:179], v[56:59]
    v_and_b32 v217, s14, v80
    v_mfma_f32_16x16x32_bf16 v[60:63], v[152:155], v[176:179], v[60:63]
    v_lshlrev_b32 v218, 16, v81
    v_mfma_f32_16x16x32_bf16 v[52:55], v[144:147], v[176:179], v[52:55]
    v_and_b32 v219, s14, v81
    v_mfma_f32_16x16x32_bf16 v[60:63], v[140:143], v[188:191], v[60:63]
    v_fma_f32 v200, v216, v88, v89
    v_mfma_f32_16x16x32_bf16 v[52:55], v[140:143], v[180:183], v[52:55]
    v_fma_f32 v201, v217, v90, v91
    v_mfma_f32_16x16x32_bf16 v[56:59], v[140:143], v[184:187], v[56:59]
    v_fma_f32 v202, v218, v92, v93
    v_mfma_f32_16x16x32_bf16 v[64:67], v[140:143], v[192:195], v[64:67]
    v_fma_f32 v203, v219, v94, v95
    v_mfma_f32_16x16x32_bf16 v[56:59], v[152:155], v[172:175], v[56:59]
    s_waitcnt lgkmcnt(6)
    v_lshlrev_b32 v220, 16, v82
    v_mfma_f32_16x16x32_bf16 v[64:67], v[160:163], v[172:175], v[64:67]
    v_and_b32 v221, s14, v82
    v_mfma_f32_16x16x32_bf16 v[52:55], v[148:151], v[172:175], v[52:55]
    v_lshlrev_b32 v222, 16, v83
    v_mfma_f32_16x16x32_bf16 v[60:63], v[156:159], v[172:175], v[60:63]
    v_and_b32 v223, s14, v83
    v_mfma_f32_16x16x32_bf16 v[52:55], v[136:139], v[184:187], v[52:55]
    v_fma_f32 v204, v220, v96, v97
    v_mfma_f32_16x16x32_bf16 v[60:63], v[136:139], v[192:195], v[60:63]
    v_fma_f32 v205, v221, v98, v99
    v_mfma_f32_16x16x32_bf16 v[64:67], v[136:139], v[196:199], v[64:67]
    v_fma_f32 v206, v222, v100, v101
    v_mfma_f32_16x16x32_bf16 v[56:59], v[136:139], v[188:191], v[56:59]
    v_fma_f32 v207, v223, v102, v103
    v_mfma_f32_16x16x32_bf16 v[64:67], v[164:167], v[168:171], v[64:67]
    s_waitcnt lgkmcnt(3)
    v_lshlrev_b32 v224, 16, v84
    v_mfma_f32_16x16x32_bf16 v[56:59], v[156:159], v[168:171], v[56:59]
    v_and_b32 v225, s14, v84
    v_mfma_f32_16x16x32_bf16 v[60:63], v[160:163], v[168:171], v[60:63]
    v_lshlrev_b32 v226, 16, v85
    v_mfma_f32_16x16x32_bf16 v[52:55], v[152:155], v[168:171], v[52:55]
    v_and_b32 v227, s14, v85
    v_mfma_f32_16x16x32_bf16 v[48:51], v[140:143], v[176:179], v[48:51]
    v_fma_f32 v208, v224, v104, v105
    v_mfma_f32_16x16x32_bf16 v[44:47], v[140:143], v[172:175], v[44:47]
    v_fma_f32 v209, v225, v106, v107
    v_mfma_f32_16x16x32_bf16 v[48:51], v[144:147], v[172:175], v[48:51]
    v_fma_f32 v210, v226, v108, v109
    v_mfma_f32_16x16x32_bf16 v[44:47], v[136:139], v[176:179], v[44:47]
    v_fma_f32 v211, v227, v110, v111
    v_mfma_f32_16x16x32_bf16 v[48:51], v[136:139], v[180:183], v[48:51]
    ds_write_b128 v34, v[52:55] offset:0
    v_mfma_f32_16x16x32_bf16 v[40:43], v[136:139], v[172:175], v[40:43]
    ds_write_b128 v34, v[56:59] offset:1024
    v_mfma_f32_16x16x32_bf16 v[48:51], v[148:151], v[168:171], v[48:51]
    ds_write_b128 v34, v[60:63] offset:2048
    v_mfma_f32_16x16x32_bf16 v[40:43], v[140:143], v[168:171], v[40:43]
    ds_write_b128 v34, v[64:67] offset:3072
    ds_write_b32 v16, v19
    v_mfma_f32_16x16x32_bf16 v[44:47], v[144:147], v[168:171], v[44:47]
    s_waitcnt lgkmcnt(5)
    v_lshlrev_b32 v228, 16, v86
    ds_read_b32 v20, v17
    v_mfma_f32_16x16x32_bf16 v[36:39], v[136:139], v[168:171], v[36:39]
    v_and_b32 v229, s14, v86
    v_lshlrev_b32 v230, 16, v87
    v_and_b32 v231, s14, v87
    v_fma_f32 v212, v228, v112, v113
    v_fma_f32 v213, v229, v114, v115
    v_fma_f32 v214, v230, v116, v117
    v_fma_f32 v215, v231, v118, v119
L_pw1:
    s_waitcnt lgkmcnt(0)
    v_cmp_ne_u32 vcc, 1, v20
    s_cbranch_vccz L_pwx1
    ds_read_b32 v20, v17
    s_branch L_pw1
L_pwx1:
    ds_read_b128 v[72:75], v35 offset:0
    ds_read_b128 v[76:79], v35 offset:1024
    ds_read_b128 v[80:83], v35 offset:2048
    ds_read_b128 v[84:87], v35 offset:3072
    s_waitcnt lgkmcnt(3)
    v_pk_add_f32 v[36:37], v[36:37], v[72:73]
    v_pk_add_f32 v[38:39], v[38:39], v[74:75]
    v_pk_fma_f32 v[36:37], v[200:201], v[36:37], v[216:217]
    v_pk_fma_f32 v[38:39], v[202:203], v[38:39], v[218:219]
    v_cvt_pk_bf16_f32 v124, v36, v37
    v_cvt_pk_bf16_f32 v125, v38, v39
    s_waitcnt lgkmcnt(2)
    v_pk_add_f32 v[40:41], v[40:41], v[76:77]
    v_pk_add_f32 v[42:43], v[42:43], v[78:79]
    v_pk_fma_f32 v[40:41], v[204:205], v[40:41], v[220:221]
    v_pk_fma_f32 v[42:43], v[206:207], v[42:43], v[222:223]
    v_cvt_pk_bf16_f32 v126, v40, v41
    v_cvt_pk_bf16_f32 v127, v42, v43
    s_nop 1
    v_permlane16_swap_b32 v124, v126
    v_permlane16_swap_b32 v125, v127
    buffer_store_dwordx4 v[124:127], v14, s[40:43], s18 offen sc1
    s_waitcnt lgkmcnt(1)
    v_pk_add_f32 v[44:45], v[44:45], v[80:81]
    v_pk_add_f32 v[46:47], v[46:47], v[82:83]
    v_pk_fma_f32 v[44:45], v[208:209], v[44:45], v[224:225]
    v_pk_fma_f32 v[46:47], v[210:211], v[46:47], v[226:227]
    v_cvt_pk_bf16_f32 v128, v44, v45
    v_cvt_pk_bf16_f32 v129, v46, v47
    s_waitcnt lgkmcnt(0)
    v_pk_add_f32 v[48:49], v[48:49], v[84:85]
    v_pk_add_f32 v[50:51], v[50:51], v[86:87]
    v_pk_fma_f32 v[48:49], v[212:213], v[48:49], v[228:229]
    v_pk_fma_f32 v[50:51], v[214:215], v[50:51], v[230:231]
    v_cvt_pk_bf16_f32 v130, v48, v49
    v_cvt_pk_bf16_f32 v131, v50, v51
    s_nop 1
    v_permlane16_swap_b32 v128, v130
    v_permlane16_swap_b32 v129, v131
    buffer_store_dwordx4 v[128:131], v14, s[40:43], s19 offen sc1
    s_branch L_conv_j
L_conv_h0:
    v_mfma_f32_16x16x32_bf16 v[48:51], v[140:143], v[176:179], v[48:51]
    ds_read_b64 v[80:81], v10 offset:0
    ds_read_b128 v[88:91], v13 offset:0
    v_mfma_f32_16x16x32_bf16 v[44:47], v[140:143], v[172:175], v[44:47]
    ds_read_b128 v[92:95], v13 offset:1024
    ds_read_b64 v[82:83], v10 offset:512
    v_mfma_f32_16x16x32_bf16 v[48:51], v[144:147], v[172:175], v[48:51]
    ds_read_b128 v[96:99], v13 offset:2048
    ds_read_b128 v[100:103], v13 offset:3072
    v_mfma_f32_16x16x32_bf16 v[44:47], v[136:139], v[176:179], v[44:47]
    ds_read_b64 v[84:85], v10 offset:1024
    ds_read_b128 v[104:107], v13 offset:4096
    v_mfma_f32_16x16x32_bf16 v[48:51], v[136:139], v[180:183], v[48:51]
    ds_read_b128 v[108:111], v13 offset:5120
    ds_read_b64 v[86:87], v10 offset:1536
    v_mfma_f32_16x16x32_bf16 v[40:43], v[136:139], v[172:175], v[40:43]
    ds_read_b128 v[112:115], v13 offset:6144
    ds_read_b128 v[116:119], v13 offset:7168
    v_mfma_f32_16x16x32_bf16 v[48:51], v[148:151], v[168:171], v[48:51]
    s_waitcnt lgkmcnt(9)
    v_lshlrev_b32 v216, 16, v80
    v_mfma_f32_16x16x32_bf16 v[40:43], v[140:143], v[168:171], v[40:43]
    v_and_b32 v217, s14, v80
    v_mfma_f32_16x16x32_bf16 v[44:47], v[144:147], v[168:171], v[44:47]
    v_lshlrev_b32 v218, 16, v81
    v_mfma_f32_16x16x32_bf16 v[36:39], v[136:139], v[168:171], v[36:39]
    v_and_b32 v219, s14, v81
    v_mfma_f32_16x16x32_bf16 v[64:67], v[148:151], v[184:187], v[64:67]
    v_fma_f32 v200, v216, v88, v89
    v_mfma_f32_16x16x32_bf16 v[60:63], v[148:151], v[180:183], v[60:63]
    v_fma_f32 v201, v217, v90, v91
    v_mfma_f32_16x16x32_bf16 v[64:67], v[152:155], v[180:183], v[64:67]
    v_fma_f32 v202, v218, v92, v93
    v_mfma_f32_16x16x32_bf16 v[60:63], v[144:147], v[184:187], v[60:63]
    v_fma_f32 v203, v219, v94, v95
    v_mfma_f32_16x16x32_bf16 v[64:67], v[144:147], v[188:191], v[64:67]
    ds_write_b128 v34, v[36:39] offset:0
    v_mfma_f32_16x16x32_bf16 v[56:59], v[144:147], v[180:183], v[56:59]
    ds_write_b128 v34, v[40:43] offset:1024
    v_mfma_f32_16x16x32_bf16 v[64:67], v[156:159], v[176:179], v[64:67]
    ds_write_b128 v34, v[44:47] offset:2048
    v_mfma_f32_16x16x32_bf16 v[56:59], v[148:151], v[176:179], v[56:59]
    ds_write_b128 v34, v[48:51] offset:3072
    ds_write_b32 v16, v19
    v_mfma_f32_16x16x32_bf16 v[60:63], v[152:155], v[176:179], v[60:63]
    s_waitcnt lgkmcnt(11)
    v_lshlrev_b32 v220, 16, v82
    v_mfma_f32_16x16x32_bf16 v[52:55], v[144:147], v[176:179], v[52:55]
    v_and_b32 v221, s14, v82
    v_mfma_f32_16x16x32_bf16 v[60:63], v[140:143], v[188:191], v[60:63]
    v_lshlrev_b32 v222, 16, v83
    v_mfma_f32_16x16x32_bf16 v[52:55], v[140:143], v[180:183], v[52:55]
    v_and_b32 v223, s14, v83
    v_mfma_f32_16x16x32_bf16 v[56:59], v[140:143], v[184:187], v[56:59]
    v_fma_f32 v204, v220, v96, v97
    v_mfma_f32_16x16x32_bf16 v[64:67], v[140:143], v[192:195], v[64:67]
    v_fma_f32 v205, v221, v98, v99
    v_mfma_f32_16x16x32_bf16 v[56:59], v[152:155], v[172:175], v[56:59]
    v_fma_f32 v206, v222, v100, v101
    v_mfma_f32_16x16x32_bf16 v[64:67], v[160:163], v[172:175], v[64:67]
    v_fma_f32 v207, v223, v102, v103
    v_mfma_f32_16x16x32_bf16 v[52:55], v[148:151], v[172:175], v[52:55]
    s_waitcnt lgkmcnt(8)
    v_lshlrev_b32 v224, 16, v84
    v_mfma_f32_16x16x32_bf16 v[60:63], v[156:159], v[172:175], v[60:63]
    v_and_b32 v225, s14, v84
    v_mfma_f32_16x16x32_bf16 v[52:55], v[136:139], v[184:187], v[52:55]
    v_lshlrev_b32 v226, 16, v85
    v_mfma_f32_16x16x32_bf16 v[60:63], v[136:139], v[192:195], v[60:63]
    v_and_b32 v227, s14, v85
    v_mfma_f32_16x16x32_bf16 v[64:67], v[136:139], v[196:199], v[64:67]
    v_fma_f32 v208, v224, v104, v105
    v_mfma_f32_16x16x32_bf16 v[56:59], v[136:139], v[188:191], v[56:59]
    v_fma_f32 v209, v225, v106, v107
    v_mfma_f32_16x16x32_bf16 v[64:67], v[164:167], v[168:171], v[64:67]
    v_fma_f32 v210, v226, v108, v109
    v_mfma_f32_16x16x32_bf16 v[56:59], v[156:159], v[168:171], v[56:59]
    v_fma_f32 v211, v227, v110, v111
    v_mfma_f32_16x16x32_bf16 v[60:63], v[160:163], v[168:171], v[60:63]
    s_waitcnt lgkmcnt(5)
    v_lshlrev_b32 v228, 16, v86
    ds_read_b32 v20, v17
    v_mfma_f32_16x16x32_bf16 v[52:55], v[152:155], v[168:171], v[52:55]
    v_and_b32 v229, s14, v86
    v_lshlrev_b32 v230, 16, v87
    v_and_b32 v231, s14, v87
    v_fma_f32 v212, v228, v112, v113
    v_fma_f32 v213, v229, v114, v115
    v_fma_f32 v214, v230, v116, v117
    v_fma_f32 v215, v231, v118, v119
L_pw2:
    s_waitcnt lgkmcnt(0)
    v_cmp_ne_u32 vcc, 1, v20
    s_cbranch_vccz L_pwx2
    ds_read_b32 v20, v17
    s_branch L_pw2
L_pwx2:
    ds_read_b128 v[72:75], v35 offset:0
    ds_read_b128 v[76:79], v35 offset:1024
    ds_read_b128 v[80:83], v35 offset:2048
    ds_read_b128 v[84:87], v35 offset:3072
    s_waitcnt lgkmcnt(3)
    v_pk_add_f32 v[52:53], v[52:53], v[72:73]
    v_pk_add_f32 v[54:55], v[54:55], v[74:75]
    v_pk_fma_f32 v[52:53], v[200:201], v[52:53], v[216:217]
    v_pk_fma_f32 v[54:55], v[202:203], v[54:55], v[218:219]
    v_cvt_pk_bf16_f32 v124, v52, v53
    v_cvt_pk_bf16_f32 v125, v54, v55
    s_waitcnt lgkmcnt(2)
    v_pk_add_f32 v[56:57], v[56:57], v[76:77]
    v_pk_add_f32 v[58:59], v[58:59], v[78:79]
    v_pk_fma_f32 v[56:57], v[204:205], v[56:57], v[220:221]
    v_pk_fma_f32 v[58:59], v[206:207], v[58:59], v[222:223]
    v_cvt_pk_bf16_f32 v126, v56, v57
    v_cvt_pk_bf16_f32 v127, v58, v59
    s_nop 1
    v_permlane16_swap_b32 v124, v126
    v_permlane16_swap_b32 v125, v127
    buffer_store_dwordx4 v[124:127], v14, s[40:43], s18 offen sc1
    s_waitcnt lgkmcnt(1)
    v_pk_add_f32 v[60:61], v[60:61], v[80:81]
    v_pk_add_f32 v[62:63], v[62:63], v[82:83]
    v_pk_fma_f32 v[60:61], v[208:209], v[60:61], v[224:225]
    v_pk_fma_f32 v[62:63], v[210:211], v[62:63], v[226:227]
    v_cvt_pk_bf16_f32 v128, v60, v61
    v_cvt_pk_bf16_f32 v129, v62, v63
    s_waitcnt lgkmcnt(0)
    v_pk_add_f32 v[64:65], v[64:65], v[84:85]
    v_pk_add_f32 v[66:67], v[66:67], v[86:87]
    v_pk_fma_f32 v[64:65], v[212:213], v[64:65], v[228:229]
    v_pk_fma_f32 v[66:67], v[214:215], v[66:67], v[230:231]
    v_cvt_pk_bf16_f32 v130, v64, v65
    v_cvt_pk_bf16_f32 v131, v66, v67
    s_nop 1
    v_permlane16_swap_b32 v128, v130
    v_permlane16_swap_b32 v129, v131
    buffer_store_dwordx4 v[128:131], v14, s[40:43], s19 offen sc1
L_conv_j:
    v_and_b32 v3, 15, v2
    v_lshrrev_b32 v4, 4, v2
    v_lshrrev_b32 v5, 2, v3
    v_and_b32 v6, 3, v3
    v_lshrrev_b32 v7, 5, v2
    v_and_b32 v8, 1, v4
    v_lshl_add_u32 v9, v7, 3, v5
    v_lshlrev_b32 v10, 8, v9
    v_lshl_add_u32 v10, v8, 5, v10
    v_lshl_add_u32 v10, v6, 3, v10
    v_add_u32 v10, 98560, v10
    v_mul_u32_u24 v12, 192, v9
    v_mul_u32_u24 v13, 12320, v8
    v_add_u32 v12, v12, v13
    v_lshl_add_u32 v12, v6, 3, v12
    s_min_u32 s26, s11, 2
    s_lshl_b32 s16, s26, 6
    s_mul_i32 s17, s10, 6144
    s_add_u32 s16, s16, s17
    v_add_u32 v28, s16, v12
    s_mul_i32 s15, s21, 96
    v_add_u32 v12, s15, v12
    s_lshl_b32 s15, s20, 1
    v_xor_b32 v13, s15, v5
    v_lshl_add_u32 v13, v13, 6, v10
    s_add_u32 s15, s15, 1
    v_xor_b32 v18, s15, v5
    v_lshl_add_u32 v18, v18, 6, v10
    v_mov_b32 v15, v12
    v_mov_b32 v16, v13
    v_mov_b32 v17, v18
    s_waitcnt vmcnt(0)
    s_barrier
    v_and_b32 v9, 31, v2
    v_mov_b32 v200, 0
    v_mov_b32 v201, 0
    v_mov_b32 v202, 0
    v_mov_b32 v203, 0
    v_mov_b32 v204, 0
    v_mov_b32 v205, 0
    v_mov_b32 v206, 0
    v_mov_b32 v207, 0
    v_mov_b32 v208, 0
    v_mov_b32 v209, 0
    v_mov_b32 v210, 0
    v_mov_b32 v211, 0
    v_mov_b32 v212, 0
    v_mov_b32 v213, 0
    v_mov_b32 v214, 0
    v_mov_b32 v215, 0
    v_mov_b32 v216, 0
    v_mov_b32 v217, 0
    v_mov_b32 v218, 0
    v_mov_b32 v219, 0
    s_and_b32 s27, s77, 1
    s_lshl_b32 s27, s27, 6
    s_lshl_b32 s15, s20, 5
    s_add_u32 s27, s27, s15
    v_add_u32 v61, s27, v9
    v_lshlrev_b32 v62, 2, v61
    v_lshrrev_b32 v24, 3, v61
    v_and_b32 v25, 7, v61
    v_lshlrev_b32 v25, 1, v25
    v_lshl_add_u32 v25, v7, 10, v25
    v_xor_b32 v26, 0, v24
    v_lshl_add_u32 v241, v26, 4, v25
    v_xor_b32 v26, 4, v24
    v_lshl_add_u32 v242, v26, 4, v25
    v_xor_b32 v26, 8, v24
    v_lshl_add_u32 v243, v26, 4, v25
    v_xor_b32 v26, 12, v24
    v_lshl_add_u32 v244, v26, 4, v25
    s_lshl_b32 s15, s13, 7
    v_add_u32 v245, s15, v61
    v_lshlrev_b32 v245, 10, v245
    v_lshl_add_u32 v245, v7, 4, v245
    v_lshl_add_u32 v24, v7, 2, v5
    v_lshlrev_b32 v24, 7, v24
    v_lshl_add_u32 v24, v8, 5, v24
    v_lshl_add_u32 v24, v6, 3, v24
    s_lshl_b32 s15, s21, 13
    v_add_u32 v24, s15, v24
    v_lshrrev_b32 v25, 3, v3
    v_xor_b32 v25, s21, v25
    v_lshl_add_u32 v246, v25, 6, v24
    v_xor_b32 v25, 1, v25
    v_lshl_add_u32 v247, v25, 6, v24
    v_lshlrev_b32 v11, 4, v2
    s_lshl_b32 s17, s6, 2
    s_lshl_b32 s18, s20, 1
    s_add_u32 s17, s17, s18
    s_mul_i32 s17, s17, 96
    s_lshl_b32 s19, s7, 1
    s_add_u32 s19, s19, s21
    s_add_u32 s17, s17, s19
    s_lshl_b32 s17, s17, 10
    s_add_u32 s17, s17, 0x710000
    s_add_u32 s18, s17, 98304
    s_lshl_b32 s15, s6, 1
    s_add_u32 s15, s15, s20
    s_lshl_b32 s15, s15, 9
    s_add_u32 s15, s15, 0x440000
    v_mov_b32 v253, s15
    v_mov_b32 v248, 1
    v_mov_b32 v224, 0
    v_mov_b32 v225, 0
    v_mov_b32 v226, 0
    v_mov_b32 v227, 0
    v_mov_b32 v228, 0
    v_mov_b32 v229, 0
    v_mov_b32 v230, 0
    v_mov_b32 v231, 0
    v_mov_b32 v232, 0
    v_mov_b32 v233, 0
    v_mov_b32 v234, 0
    v_mov_b32 v235, 0
    v_mov_b32 v236, 0
    v_mov_b32 v237, 0
    v_mov_b32 v238, 0
    v_mov_b32 v239, 0
    s_cmp_eq_u32 s7, 15
    s_cbranch_scc0 L_c_p3
    s_lshl_b32 s15, s11, 6
    v_add_u32 v20, s15, v2
    v_lshlrev_b32 v28, 3, v20
    v_mov_b32 v248, 0
    s_barrier
    s_barrier
    s_mul_i32 s16, s6, 24576
    s_add_u32 s16, s16, 0x468000
    buffer_load_dwordx2 v[64:65], v28, s[40:43], s16 offen offset:0 sc1
    buffer_load_dwordx2 v[66:67], v28, s[40:43], s16 offen offset:1536 sc1
    s_add_u32 s16, s16, 3072
    buffer_load_dwordx2 v[68:69], v28, s[40:43], s16 offen offset:0 sc1
    buffer_load_dwordx2 v[70:71], v28, s[40:43], s16 offen offset:1536 sc1
    s_add_u32 s16, s16, 3072
    buffer_load_dwordx2 v[72:73], v28, s[40:43], s16 offen offset:0 sc1
    buffer_load_dwordx2 v[74:75], v28, s[40:43], s16 offen offset:1536 sc1
    s_add_u32 s16, s16, 3072
    buffer_load_dwordx2 v[76:77], v28, s[40:43], s16 offen offset:0 sc1
    buffer_load_dwordx2 v[78:79], v28, s[40:43], s16 offen offset:1536 sc1
    s_add_u32 s16, s16, 3072
    buffer_load_dwordx2 v[80:81], v28, s[40:43], s16 offen offset:0 sc1
    buffer_load_dwordx2 v[82:83], v28, s[40:43], s16 offen offset:1536 sc1
    s_add_u32 s16, s16, 3072
    buffer_load_dwordx2 v[84:85], v28, s[40:43], s16 offen offset:0 sc1
    buffer_load_dwordx2 v[86:87], v28, s[40:43], s16 offen offset:1536 sc1
    s_add_u32 s16, s16, 3072
    buffer_load_dwordx2 v[88:89], v28, s[40:43], s16 offen offset:0 sc1
    buffer_load_dwordx2 v[90:91], v28, s[40:43], s16 offen offset:1536 sc1
    s_add_u32 s16, s16, 3072
    buffer_load_dwordx2 v[92:93], v28, s[40:43], s16 offen offset:0 sc1
    buffer_load_dwordx2 v[94:95], v28, s[40:43], s16 offen offset:1536 sc1
    s_barrier
    s_cmp_eq_u32 s6, 15
    s_cbranch_scc1 L_c_sp2
    s_cmp_eq_u32 s11, 3
    s_cbranch_scc1 L_c_sp2
    s_mov_b32 s30, 0x100000
L_c_sp1:
    s_waitcnt vmcnt(0)
    v_xor_b32 v50, s9, v65
    v_xor_b32 v51, s9, v67
    v_or_b32 v50, v50, v51
    v_xor_b32 v51, s9, v69
    v_or_b32 v50, v50, v51
    v_xor_b32 v51, s9, v71
    v_or_b32 v50, v50, v51
    v_xor_b32 v51, s9, v73
    v_or_b32 v50, v50, v51
    v_xor_b32 v51, s9, v75
    v_or_b32 v50, v50, v51
    v_xor_b32 v51, s9, v77
    v_or_b32 v50, v50, v51
    v_xor_b32 v51, s9, v79
    v_or_b32 v50, v50, v51
    v_xor_b32 v51, s9, v81
    v_or_b32 v50, v50, v51
    v_xor_b32 v51, s9, v83
    v_or_b32 v50, v50, v51
    v_xor_b32 v51, s9, v85
    v_or_b32 v50, v50, v51
    v_xor_b32 v51, s9, v87
    v_or_b32 v50, v50, v51
    v_xor_b32 v51, s9, v89
    v_or_b32 v50, v50, v51
    v_xor_b32 v51, s9, v91
    v_or_b32 v50, v50, v51
    v_xor_b32 v51, s9, v93
    v_or_b32 v50, v50, v51
    v_xor_b32 v51, s9, v95
    v_or_b32 v50, v50, v51
    v_cmp_ne_u32 vcc, 0, v50
    s_cbranch_vccz L_c_sp1x
    s_sub_u32 s30, s30, 1
    s_cbranch_scc1 L_c_sp1x
    s_mul_i32 s16, s6, 24576
    s_add_u32 s16, s16, 0x468000
    buffer_load_dwordx2 v[64:65], v28, s[40:43], s16 offen offset:0 sc1
    buffer_load_dwordx2 v[66:67], v28, s[40:43], s16 offen offset:1536 sc1
    s_add_u32 s16, s16, 3072
    buffer_load_dwordx2 v[68:69], v28, s[40:43], s16 offen offset:0 sc1
    buffer_load_dwordx2 v[70:71], v28, s[40:43], s16 offen offset:1536 sc1
    s_add_u32 s16, s16, 3072
    buffer_load_dwordx2 v[72:73], v28, s[40:43], s16 offen offset:0 sc1
    buffer_load_dwordx2 v[74:75], v28, s[40:43], s16 offen offset:1536 sc1
    s_add_u32 s16, s16, 3072
    buffer_load_dwordx2 v[76:77], v28, s[40:43], s16 offen offset:0 sc1
    buffer_load_dwordx2 v[78:79], v28, s[40:43], s16 offen offset:1536 sc1
    s_add_u32 s16, s16, 3072
    buffer_load_dwordx2 v[80:81], v28, s[40:43], s16 offen offset:0 sc1
    buffer_load_dwordx2 v[82:83], v28, s[40:43], s16 offen offset:1536 sc1
    s_add_u32 s16, s16, 3072
    buffer_load_dwordx2 v[84:85], v28, s[40:43], s16 offen offset:0 sc1
    buffer_load_dwordx2 v[86:87], v28, s[40:43], s16 offen offset:1536 sc1
    s_add_u32 s16, s16, 3072
    buffer_load_dwordx2 v[88:89], v28, s[40:43], s16 offen offset:0 sc1
    buffer_load_dwordx2 v[90:91], v28, s[40:43], s16 offen offset:1536 sc1
    s_add_u32 s16, s16, 3072
    buffer_load_dwordx2 v[92:93], v28, s[40:43], s16 offen offset:0 sc1
    buffer_load_dwordx2 v[94:95], v28, s[40:43], s16 offen offset:1536 sc1
    s_branch L_c_sp1
L_c_sp1x:
    v_add_f32 v64, v64, v66
    v_add_f32 v64, v64, v68
    v_add_f32 v64, v64, v70
    v_add_f32 v64, v64, v72
    v_add_f32 v64, v64, v74
    v_add_f32 v64, v64, v76
    v_add_f32 v64, v64, v78
    v_add_f32 v64, v64, v80
    v_add_f32 v64, v64, v82
    v_add_f32 v64, v64, v84
    v_add_f32 v64, v64, v86
    v_add_f32 v64, v64, v88
    v_add_f32 v64, v64, v90
    v_add_f32 v64, v64, v92
    v_add_f32 v64, v64, v94
    v_mov_b32 v54, 0
    v_cvt_pk_bf16_f32 v53, v64, v54
    v_lshlrev_b32 v51, 16, v53
    v_sub_f32 v51, v64, v51
    v_cvt_pk_bf16_f32 v52, v64, v51
    v_mov_b32 v55, v254
    v_lshlrev_b32 v28, 4, v20
    s_mul_i32 s16, s6, 3072
    s_add_u32 s16, s16, 0x450000
    buffer_store_dwordx4 v[52:55], v28, s[40:43], s16 offen sc1
L_c_sp2:
    s_barrier
    s_barrier
    s_branch L_c_p4
L_c_p3:
    ds_read_b64_tr_b16 v[32:33], v28 offset:0
    ds_read_b64_tr_b16 v[34:35], v28 offset:768
    ds_read_b64_tr_b16 v[36:37], v28 offset:3072
    ds_read_b64_tr_b16 v[38:39], v28 offset:3840
    ds_read_b64_tr_b16 v[40:41], v28 offset:32
    ds_read_b64_tr_b16 v[42:43], v28 offset:800
    ds_read_b64_tr_b16 v[44:45], v28 offset:3104
    ds_read_b64_tr_b16 v[46:47], v28 offset:3872
    v_mov_b32 v30, 0
    v_mov_b32 v31, 0
    s_mov_b32 s27, 0x3f803f80
    s_lshl_b32 s16, s7, 4
    s_add_u32 s16, s16, s6
    s_mul_i32 s16, s16, 1536
    s_lshl_b32 s15, s26, 9
    s_add_u32 s16, s16, s15
    s_add_u32 s16, s16, 0x468000
    v_lshlrev_b32 v29, 3, v2
    s_waitcnt lgkmcnt(0)
    v_dot2_f32_bf16 v30, v32, s27, v30
    v_dot2_f32_bf16 v31, v40, s27, v31
    v_dot2_f32_bf16 v30, v33, s27, v30
    v_dot2_f32_bf16 v31, v41, s27, v31
    v_dot2_f32_bf16 v30, v34, s27, v30
    v_dot2_f32_bf16 v31, v42, s27, v31
    v_dot2_f32_bf16 v30, v35, s27, v30
    v_dot2_f32_bf16 v31, v43, s27, v31
    v_dot2_f32_bf16 v30, v36, s27, v30
    v_dot2_f32_bf16 v31, v44, s27, v31
    v_dot2_f32_bf16 v30, v37, s27, v30
    v_dot2_f32_bf16 v31, v45, s27, v31
    v_dot2_f32_bf16 v30, v38, s27, v30
    v_dot2_f32_bf16 v31, v46, s27, v31
    v_dot2_f32_bf16 v30, v39, s27, v30
    v_dot2_f32_bf16 v31, v47, s27, v31
    s_nop 3
    v_permlane32_swap_b32 v30, v31
    s_nop 1
    v_add_f32 v30, v30, v31
    v_mov_b32 v250, v30
    v_mov_b32 v251, v254
    v_mov_b32 v249, v29
    s_cmp_eq_u32 s11, 3
    s_cselect_b32 s16, 0x7f000000, s16
    buffer_store_dwordx2 v[250:251], v249, s[40:43], s16 offen sc1
    v_mov_b32 v64, 0
    v_mov_b32 v65, 0
    v_mov_b32 v66, 0
    v_mov_b32 v67, 0
    v_mov_b32 v68, 0
    v_mov_b32 v69, 0
    v_mov_b32 v70, 0
    v_mov_b32 v71, 0
    v_mov_b32 v72, 0
    v_mov_b32 v73, 0
    v_mov_b32 v74, 0
    v_mov_b32 v75, 0
    v_mov_b32 v76, 0
    v_mov_b32 v77, 0
    v_mov_b32 v78, 0
    v_mov_b32 v79, 0
    v_mov_b32 v80, 0
    v_mov_b32 v81, 0
    v_mov_b32 v82, 0
    v_mov_b32 v83, 0
    v_mov_b32 v84, 0
    v_mov_b32 v85, 0
    v_mov_b32 v86, 0
    v_mov_b32 v87, 0
    v_mov_b32 v88, 0
    v_mov_b32 v89, 0
    v_mov_b32 v90, 0
    v_mov_b32 v91, 0
    v_mov_b32 v92, 0
    v_mov_b32 v93, 0
    v_mov_b32 v94, 0
    v_mov_b32 v95, 0
    v_mov_b32 v96, 0
    v_mov_b32 v97, 0
    v_mov_b32 v98, 0
    v_mov_b32 v99, 0
    v_mov_b32 v100, 0
    v_mov_b32 v101, 0
    v_mov_b32 v102, 0
    v_mov_b32 v103, 0
    v_mov_b32 v104, 0
    v_mov_b32 v105, 0
    v_mov_b32 v106, 0
    v_mov_b32 v107, 0
    v_mov_b32 v108, 0
    v_mov_b32 v109, 0
    v_mov_b32 v110, 0
    v_mov_b32 v111, 0
    v_mov_b32 v112, 0
    v_mov_b32 v113, 0
    v_mov_b32 v114, 0
    v_mov_b32 v115, 0
    v_mov_b32 v116, 0
    v_mov_b32 v117, 0
    v_mov_b32 v118, 0
    v_mov_b32 v119, 0
    v_mov_b32 v120, 0
    v_mov_b32 v121, 0
    v_mov_b32 v122, 0
    v_mov_b32 v123, 0
    v_mov_b32 v124, 0
    v_mov_b32 v125, 0
    v_mov_b32 v126, 0
    v_mov_b32 v127, 0
    v_mov_b32 v128, 0
    v_mov_b32 v129, 0
    v_mov_b32 v130, 0
    v_mov_b32 v131, 0
    v_mov_b32 v132, 0
    v_mov_b32 v133, 0
    v_mov_b32 v134, 0
    v_mov_b32 v135, 0
    v_mov_b32 v136, 0
    v_mov_b32 v137, 0
    v_mov_b32 v138, 0
    v_mov_b32 v139, 0
    v_mov_b32 v140, 0
    v_mov_b32 v141, 0
    v_mov_b32 v142, 0
    v_mov_b32 v143, 0
    v_mov_b32 v144, 0
    v_mov_b32 v145, 0
    v_mov_b32 v146, 0
    v_mov_b32 v147, 0
    v_mov_b32 v148, 0
    v_mov_b32 v149, 0
    v_mov_b32 v150, 0
    v_mov_b32 v151, 0
    v_mov_b32 v152, 0
    v_mov_b32 v153, 0
    v_mov_b32 v154, 0
    v_mov_b32 v155, 0
    v_mov_b32 v156, 0
    v_mov_b32 v157, 0
    v_mov_b32 v158, 0
    v_mov_b32 v159, 0
    s_mul_i32 s22, s7, 3072
    s_mul_i32 s15, s21, 1536
    s_add_u32 s22, s22, s15
    s_add_u32 s22, s22, 0x450000
    s_lshl_b32 s23, s6, 11
    s_lshl_b32 s15, s20, 10
    s_add_u32 s23, s23, s15
    s_add_u32 s23, s23, 0x448000
    s_mul_i32 s15, s21, 1536
    s_add_u32 s15, s15, 147712
    v_add_u32 v19, s15, v11
    s_lshl_b32 s15, s20, 10
    s_add_u32 s15, s15, 150784
    v_add_u32 v14, s15, v11
    s_mov_b32 s24, 0
    s_mov_b32 s25, 0
    s_mov_b32 s26, 0
    v_add_u32 v220, 24640, v12
    v_add_u32 v221, 73920, v12
    s_barrier
    s_barrier
    s_cmp_lg_u32 s19, 29
    s_cbranch_scc1 L_c_full
    s_add_u32 s15, s17, 59392
    buffer_store_dwordx4 v[64:67], v11, s[40:43], s15 offen sc1
    s_add_u32 s15, s18, 59392
    buffer_store_dwordx4 v[64:67], v11, s[40:43], s15 offen sc1
    s_waitcnt vmcnt(0)
    s_mov_b64 exec, 1
    buffer_atomic_add v248, v253, s[40:43], 0 offen offset:0 sc1
    s_mov_b64 exec, -1
    s_mov_b64 exec, 1
    buffer_atomic_add v248, v253, s[40:43], 0 offen offset:128 sc1
    s_mov_b64 exec, -1
    s_mov_b64 exec, 1
    buffer_atomic_add v248, v253, s[40:43], 0 offen offset:256 sc1
    s_mov_b64 exec, -1
    s_nop 0
    v_mov_b32 v248, 0
    s_barrier
    s_barrier
    s_barrier
    s_barrier
    s_barrier
    s_barrier
    s_barrier
    s_branch L_c_p4
L_c_full:
    ds_read_b64_tr_b16 v[20:21], v15 offset:0
    ds_read_b64_tr_b16 v[22:23], v15 offset:768
    ds_read_b64_tr_b16 v[32:33], v16 offset:0
    ds_read_b64_tr_b16 v[34:35], v16 offset:1024
    ds_read_b64_tr_b16 v[36:37], v17 offset:0
    ds_read_b64_tr_b16 v[38:39], v17 offset:1024
    ds_read_b64_tr_b16 v[24:25], v15 offset:32
    ds_read_b64_tr_b16 v[26:27], v15 offset:800
    ds_read_b64_tr_b16 v[28:29], v15 offset:64
    ds_read_b64_tr_b16 v[30:31], v15 offset:832
L_g1_loop:
    s_waitcnt lgkmcnt(0)
    v_mfma_f32_32x32x16_bf16 v[64:79], v[20:23], v[32:35], v[64:79]
    ds_read_b64_tr_b16 v[40:41], v15 offset:3072
    ds_read_b64_tr_b16 v[42:43], v15 offset:3840
    ds_read_b64_tr_b16 v[52:53], v16 offset:4096
    v_mfma_f32_32x32x16_bf16 v[80:95], v[20:23], v[36:39], v[80:95]
    ds_read_b64_tr_b16 v[54:55], v16 offset:5120
    ds_read_b64_tr_b16 v[56:57], v17 offset:4096
    ds_read_b64_tr_b16 v[58:59], v17 offset:5120
    v_mfma_f32_32x32x16_bf16 v[96:111], v[24:27], v[32:35], v[96:111]
    ds_read_b64_tr_b16 v[44:45], v15 offset:3104
    ds_read_b64_tr_b16 v[46:47], v15 offset:3872
    v_mfma_f32_32x32x16_bf16 v[112:127], v[24:27], v[36:39], v[112:127]
    ds_read_b64_tr_b16 v[48:49], v15 offset:3136
    ds_read_b64_tr_b16 v[50:51], v15 offset:3904
    v_mfma_f32_32x32x16_bf16 v[128:143], v[28:31], v[32:35], v[128:143]
    v_mfma_f32_32x32x16_bf16 v[144:159], v[28:31], v[36:39], v[144:159]
    s_waitcnt lgkmcnt(0)
    v_mfma_f32_32x32x16_bf16 v[64:79], v[40:43], v[52:55], v[64:79]
    ds_read_b64_tr_b16 v[20:21], v15 offset:6144
    ds_read_b64_tr_b16 v[22:23], v15 offset:6912
    ds_read_b64_tr_b16 v[32:33], v16 offset:8192
    v_mfma_f32_32x32x16_bf16 v[80:95], v[40:43], v[56:59], v[80:95]
    ds_read_b64_tr_b16 v[34:35], v16 offset:9216
    ds_read_b64_tr_b16 v[36:37], v17 offset:8192
    ds_read_b64_tr_b16 v[38:39], v17 offset:9216
    v_mfma_f32_32x32x16_bf16 v[96:111], v[44:47], v[52:55], v[96:111]
    ds_read_b64_tr_b16 v[24:25], v15 offset:6176
    ds_read_b64_tr_b16 v[26:27], v15 offset:6944
    v_mfma_f32_32x32x16_bf16 v[112:127], v[44:47], v[56:59], v[112:127]
    ds_read_b64_tr_b16 v[28:29], v15 offset:6208
    ds_read_b64_tr_b16 v[30:31], v15 offset:6976
    v_mfma_f32_32x32x16_bf16 v[128:143], v[48:51], v[52:55], v[128:143]
    v_mfma_f32_32x32x16_bf16 v[144:159], v[48:51], v[56:59], v[144:159]
    s_waitcnt lgkmcnt(0)
    v_mfma_f32_32x32x16_bf16 v[64:79], v[20:23], v[32:35], v[64:79]
    ds_read_b64_tr_b16 v[40:41], v15 offset:9216
    ds_read_b64_tr_b16 v[42:43], v15 offset:9984
    ds_read_b64_tr_b16 v[52:53], v16 offset:12288
    v_mfma_f32_32x32x16_bf16 v[80:95], v[20:23], v[36:39], v[80:95]
    ds_read_b64_tr_b16 v[54:55], v16 offset:13312
    ds_read_b64_tr_b16 v[56:57], v17 offset:12288
    ds_read_b64_tr_b16 v[58:59], v17 offset:13312
    v_mfma_f32_32x32x16_bf16 v[96:111], v[24:27], v[32:35], v[96:111]
    ds_read_b64_tr_b16 v[44:45], v15 offset:9248
    ds_read_b64_tr_b16 v[46:47], v15 offset:10016
    v_mfma_f32_32x32x16_bf16 v[112:127], v[24:27], v[36:39], v[112:127]
    ds_read_b64_tr_b16 v[48:49], v15 offset:9280
    ds_read_b64_tr_b16 v[50:51], v15 offset:10048
    v_mfma_f32_32x32x16_bf16 v[128:143], v[28:31], v[32:35], v[128:143]
    s_add_u32 s25, s25, 24640
    s_cmp_eq_u32 s25, 98560
    s_cselect_b32 s25, 0, s25
    s_add_u32 s26, s26, 16384
    s_cmp_eq_u32 s26, 49152
    s_cselect_b32 s26, 0, s26
    v_mfma_f32_32x32x16_bf16 v[144:159], v[28:31], v[36:39], v[144:159]
    v_add_u32 v15, s25, v12
    v_add_u32 v16, s26, v13
    v_add_u32 v17, s26, v18
    s_waitcnt lgkmcnt(0)
    s_barrier
    v_mfma_f32_32x32x16_bf16 v[64:79], v[40:43], v[52:55], v[64:79]
    ds_read_b64_tr_b16 v[20:21], v15 offset:0
    ds_read_b64_tr_b16 v[22:23], v15 offset:768
    ds_read_b64_tr_b16 v[32:33], v16 offset:0
    v_mfma_f32_32x32x16_bf16 v[80:95], v[40:43], v[56:59], v[80:95]
    ds_read_b64_tr_b16 v[34:35], v16 offset:1024
    ds_read_b64_tr_b16 v[36:37], v17 offset:0
    ds_read_b64_tr_b16 v[38:39], v17 offset:1024
    v_mfma_f32_32x32x16_bf16 v[96:111], v[44:47], v[52:55], v[96:111]
    ds_read_b64_tr_b16 v[24:25], v15 offset:32
    ds_read_b64_tr_b16 v[26:27], v15 offset:800
    v_mfma_f32_32x32x16_bf16 v[112:127], v[44:47], v[56:59], v[112:127]
    ds_read_b64_tr_b16 v[28:29], v15 offset:64
    ds_read_b64_tr_b16 v[30:31], v15 offset:832
    v_mfma_f32_32x32x16_bf16 v[128:143], v[48:51], v[52:55], v[128:143]
    v_mfma_f32_32x32x16_bf16 v[144:159], v[48:51], v[56:59], v[144:159]
    s_add_u32 s24, s24, 1
    s_cmp_lt_u32 s24, 6
    s_cbranch_scc1 L_g1_loop
    s_waitcnt lgkmcnt(0)
    v_mfma_f32_32x32x16_bf16 v[64:79], v[20:23], v[32:35], v[64:79]
    ds_read_b64_tr_b16 v[40:41], v220 offset:27712
    ds_read_b64_tr_b16 v[42:43], v220 offset:28480
    ds_read_b64_tr_b16 v[48:49], v13 offset:4096
    v_mfma_f32_32x32x16_bf16 v[80:95], v[20:23], v[36:39], v[80:95]
    ds_read_b64_tr_b16 v[50:51], v13 offset:5120
    ds_read_b64_tr_b16 v[52:53], v18 offset:4096
    ds_read_b64_tr_b16 v[54:55], v18 offset:5120
    v_mfma_f32_32x32x16_bf16 v[96:111], v[24:27], v[32:35], v[96:111]
    ds_read_b64_tr_b16 v[44:45], v220 offset:27744
    ds_read_b64_tr_b16 v[46:47], v220 offset:28512
    ds_read_b64_tr_b16 v[160:161], v220 offset:30784
    v_mfma_f32_32x32x16_bf16 v[112:127], v[24:27], v[36:39], v[112:127]
    ds_read_b64_tr_b16 v[162:163], v220 offset:31552
    ds_read_b64_tr_b16 v[168:169], v13 offset:8192
    ds_read_b64_tr_b16 v[170:171], v13 offset:9216
    v_mfma_f32_32x32x16_bf16 v[128:143], v[28:31], v[32:35], v[128:143]
    ds_read_b64_tr_b16 v[172:173], v18 offset:8192
    ds_read_b64_tr_b16 v[174:175], v18 offset:9216
    ds_read_b64_tr_b16 v[164:165], v220 offset:30816
    v_mfma_f32_32x32x16_bf16 v[144:159], v[28:31], v[36:39], v[144:159]
    ds_read_b64_tr_b16 v[166:167], v220 offset:31584
    s_waitcnt lgkmcnt(12)
    v_mfma_f32_32x32x16_bf16 v[64:79], v[40:43], v[48:51], v[64:79]
    ds_read_b64_tr_b16 v[176:177], v220 offset:33856
    ds_read_b64_tr_b16 v[178:179], v220 offset:34624
    ds_read_b64_tr_b16 v[184:185], v13 offset:12288
    s_waitcnt lgkmcnt(13)
    v_mfma_f32_32x32x16_bf16 v[80:95], v[40:43], v[52:55], v[80:95]
    ds_read_b64_tr_b16 v[186:187], v13 offset:13312
    ds_read_b64_tr_b16 v[188:189], v18 offset:12288
    ds_read_b64_tr_b16 v[190:191], v18 offset:13312
    s_waitcnt lgkmcnt(14)
    v_mfma_f32_32x32x16_bf16 v[96:111], v[44:47], v[48:51], v[96:111]
    ds_read_b64_tr_b16 v[180:181], v220 offset:33888
    ds_read_b64_tr_b16 v[182:183], v220 offset:34656
    v_mfma_f32_32x32x16_bf16 v[112:127], v[44:47], v[52:55], v[112:127]
    s_waitcnt lgkmcnt(12)
    v_mfma_f32_32x32x16_bf16 v[64:79], v[160:163], v[168:171], v[64:79]
    s_barrier
    s_mov_b32 exec_hi, 0
    ds_read_b128 v[200:203], v19 offset:0
    ds_read_b128 v[204:207], v19 offset:512
    ds_read_b128 v[208:211], v19 offset:1024
    ds_read_b128 v[212:215], v14 offset:0
    ds_read_b128 v[216:219], v14 offset:512
    s_mov_b64 exec, -1
    ds_read_b64_tr_b16 v[20:21], v221 offset:0
    ds_read_b64_tr_b16 v[22:23], v221 offset:768
    s_waitcnt lgkmcnt(14)
    v_mfma_f32_32x32x16_bf16 v[80:95], v[160:163], v[172:175], v[80:95]
    ds_read_b64_tr_b16 v[28:29], v13 offset:16384
    ds_read_b64_tr_b16 v[30:31], v13 offset:17408
    ds_read_b64_tr_b16 v[32:33], v18 offset:16384
    v_mfma_f32_32x32x16_bf16 v[96:111], v[164:167], v[168:171], v[96:111]
    ds_read_b64_tr_b16 v[34:35], v18 offset:17408
    v_mfma_f32_32x32x16_bf16 v[112:127], v[164:167], v[172:175], v[112:127]
    s_waitcnt lgkmcnt(14)
    v_mfma_f32_32x32x16_bf16 v[64:79], v[176:179], v[184:187], v[64:79]
    ds_read_b64_tr_b16 v[40:41], v221 offset:3072
    ds_read_b64_tr_b16 v[42:43], v221 offset:3840
    ds_read_b64_tr_b16 v[48:49], v13 offset:20480
    s_waitcnt lgkmcnt(14)
    v_mfma_f32_32x32x16_bf16 v[80:95], v[176:179], v[188:191], v[80:95]
    ds_read_b64_tr_b16 v[50:51], v13 offset:21504
    ds_read_b64_tr_b16 v[52:53], v18 offset:20480
    ds_read_b64_tr_b16 v[54:55], v18 offset:21504
    v_mfma_f32_32x32x16_bf16 v[96:111], v[180:183], v[184:187], v[96:111]
    v_mfma_f32_32x32x16_bf16 v[112:127], v[180:183], v[188:191], v[112:127]
    s_waitcnt lgkmcnt(8)
    v_mfma_f32_32x32x16_bf16 v[64:79], v[20:23], v[28:31], v[64:79]
    ds_read_b64_tr_b16 v[160:161], v221 offset:6144
    ds_read_b64_tr_b16 v[162:163], v221 offset:6912
    ds_read_b64_tr_b16 v[168:169], v13 offset:24576
    s_waitcnt lgkmcnt(9)
    v_mfma_f32_32x32x16_bf16 v[80:95], v[20:23], v[32:35], v[80:95]
    ds_read_b64_tr_b16 v[170:171], v13 offset:25600
    ds_read_b64_tr_b16 v[172:173], v18 offset:24576
    ds_read_b64_tr_b16 v[174:175], v18 offset:25600
    s_waitcnt lgkmcnt(8)
    v_mfma_f32_32x32x16_bf16 v[64:79], v[40:43], v[48:51], v[64:79]
    ds_read_b64_tr_b16 v[176:177], v221 offset:9216
    ds_read_b64_tr_b16 v[178:179], v221 offset:9984
    ds_read_b64_tr_b16 v[184:185], v13 offset:28672
    s_waitcnt lgkmcnt(9)
    v_mfma_f32_32x32x16_bf16 v[80:95], v[40:43], v[52:55], v[80:95]
    ds_read_b64_tr_b16 v[186:187], v13 offset:29696
    ds_read_b64_tr_b16 v[188:189], v18 offset:28672
    ds_read_b64_tr_b16 v[190:191], v18 offset:29696
    s_waitcnt lgkmcnt(8)
    v_mfma_f32_32x32x16_bf16 v[64:79], v[160:163], v[168:171], v[64:79]
    ds_read_b64_tr_b16 v[20:21], v221 offset:32
    ds_read_b64_tr_b16 v[22:23], v221 offset:800
    ds_read_b64_tr_b16 v[28:29], v13 offset:16384
    s_waitcnt lgkmcnt(9)
    v_mfma_f32_32x32x16_bf16 v[80:95], v[160:163], v[172:175], v[80:95]
    ds_read_b64_tr_b16 v[30:31], v13 offset:17408
    ds_read_b64_tr_b16 v[32:33], v18 offset:16384
    ds_read_b64_tr_b16 v[34:35], v18 offset:17408
    s_waitcnt lgkmcnt(8)
    v_mfma_f32_32x32x16_bf16 v[64:79], v[176:179], v[184:187], v[64:79]
    ds_read_b64_tr_b16 v[40:41], v221 offset:3104
    ds_read_b64_tr_b16 v[42:43], v221 offset:3872
    ds_read_b64_tr_b16 v[48:49], v13 offset:20480
    s_waitcnt lgkmcnt(9)
    v_mfma_f32_32x32x16_bf16 v[80:95], v[176:179], v[188:191], v[80:95]
    ds_read_b64_tr_b16 v[50:51], v13 offset:21504
    ds_read_b64_tr_b16 v[52:53], v18 offset:20480
    ds_read_b64_tr_b16 v[54:55], v18 offset:21504
    s_mov_b32 s30, 0x100000
L_corr:
    v_xor_b32 v60, s9, v203
    v_xor_b32 v63, s9, v207
    v_or_b32 v60, v60, v63
    v_xor_b32 v63, s9, v211
    v_or_b32 v60, v60, v63
    v_xor_b32 v63, s9, v215
    v_or_b32 v60, v60, v63
    v_xor_b32 v63, s9, v219
    v_or_b32 v60, v60, v63
    v_cmp_ne_u32 vcc, 0, v60
    s_cmp_eq_u32 vcc_lo, 0
    s_cbranch_scc1 L_corrx
    s_sub_u32 s30, s30, 1
    s_cbranch_scc1 L_corrx
    s_mov_b32 exec_hi, 0
    buffer_load_dwordx4 v[200:203], v11, s[40:43], s22 offen offset:0 sc1
    buffer_load_dwordx4 v[204:207], v11, s[40:43], s22 offen offset:512 sc1
    buffer_load_dwordx4 v[208:211], v11, s[40:43], s22 offen offset:1024 sc1
    buffer_load_dwordx4 v[212:215], v11, s[40:43], s23 offen offset:0 sc1
    buffer_load_dwordx4 v[216:219], v11, s[40:43], s23 offen offset:512 sc1
    s_mov_b64 exec, -1
    s_waitcnt vmcnt(0)
    s_branch L_corr
L_corrx:
    v_mov_b32 v203, 0
    v_mov_b32 v207, 0
    v_mov_b32 v211, 0
    v_mov_b32 v215, 0
    v_mov_b32 v219, 0
    s_nop 1
    v_mfma_f32_32x32x16_bf16 v[64:79], v[200:203], v[212:215], v[64:79]
    s_nop 6
    v_mfma_f32_32x32x16_bf16 v[80:95], v[200:203], v[216:219], v[80:95]
    s_nop 3
    v_max_f32 v64, 0, v64
    v_max_f32 v65, 0, v65
    v_max_f32 v66, 0, v66
    v_mfma_f32_32x32x16_bf16 v[96:111], v[204:207], v[212:215], v[96:111]
    v_max_f32 v67, 0, v67
    v_max_f32 v68, 0, v68
    v_max_f32 v69, 0, v69
    v_max_f32 v70, 0, v70
    v_max_f32 v71, 0, v71
    v_mul_f32 v64, v64, v72
    v_mul_f32 v65, v65, v73
    v_mfma_f32_32x32x16_bf16 v[112:127], v[204:207], v[216:219], v[112:127]
    v_mul_f32 v66, v66, v74
    v_mul_f32 v67, v67, v75
    v_mul_f32 v68, v68, v76
    v_mul_f32 v69, v69, v77
    v_mul_f32 v70, v70, v78
    v_mul_f32 v71, v71, v79
    v_cvt_pk_bf16_f32 v72, v64, v65
    v_mfma_f32_32x32x16_bf16 v[128:143], v[208:211], v[212:215], v[128:143]
    v_cvt_pk_bf16_f32 v73, v66, v67
    v_cvt_pk_bf16_f32 v74, v68, v69
    v_cvt_pk_bf16_f32 v75, v70, v71
    s_add_u32 s15, s17, 0
    buffer_store_dwordx4 v[72:75], v11, s[40:43], s15 offen sc1
    v_max_f32 v80, 0, v80
    v_max_f32 v81, 0, v81
    v_max_f32 v82, 0, v82
    v_mfma_f32_32x32x16_bf16 v[144:159], v[208:211], v[216:219], v[144:159]
    v_max_f32 v83, 0, v83
    v_max_f32 v84, 0, v84
    v_max_f32 v85, 0, v85
    v_max_f32 v86, 0, v86
    v_max_f32 v87, 0, v87
    v_mul_f32 v80, v80, v88
    v_mul_f32 v81, v81, v89
    s_waitcnt lgkmcnt(8)
    v_mfma_f32_32x32x16_bf16 v[96:111], v[20:23], v[28:31], v[96:111]
    ds_read_b64_tr_b16 v[160:161], v221 offset:6176
    ds_read_b64_tr_b16 v[162:163], v221 offset:6944
    ds_read_b64_tr_b16 v[168:169], v13 offset:24576
    v_mul_f32 v82, v82, v90
    v_mul_f32 v83, v83, v91
    v_mul_f32 v84, v84, v92
    v_mul_f32 v85, v85, v93
    s_waitcnt lgkmcnt(9)
    v_mfma_f32_32x32x16_bf16 v[112:127], v[20:23], v[32:35], v[112:127]
    ds_read_b64_tr_b16 v[170:171], v13 offset:25600
    ds_read_b64_tr_b16 v[172:173], v18 offset:24576
    ds_read_b64_tr_b16 v[174:175], v18 offset:25600
    v_mul_f32 v86, v86, v94
    v_mul_f32 v87, v87, v95
    v_cvt_pk_bf16_f32 v88, v80, v81
    v_cvt_pk_bf16_f32 v89, v82, v83
    s_waitcnt lgkmcnt(8)
    v_mfma_f32_32x32x16_bf16 v[96:111], v[40:43], v[48:51], v[96:111]
    ds_read_b64_tr_b16 v[176:177], v221 offset:9248
    ds_read_b64_tr_b16 v[178:179], v221 offset:10016
    ds_read_b64_tr_b16 v[184:185], v13 offset:28672
    v_cvt_pk_bf16_f32 v90, v84, v85
    v_cvt_pk_bf16_f32 v91, v86, v87
    s_add_u32 s15, s18, 0
    buffer_store_dwordx4 v[88:91], v11, s[40:43], s15 offen sc1
    s_waitcnt lgkmcnt(9)
    v_mfma_f32_32x32x16_bf16 v[112:127], v[40:43], v[52:55], v[112:127]
    ds_read_b64_tr_b16 v[186:187], v13 offset:29696
    ds_read_b64_tr_b16 v[188:189], v18 offset:28672
    ds_read_b64_tr_b16 v[190:191], v18 offset:29696
    s_waitcnt lgkmcnt(8)
    v_mfma_f32_32x32x16_bf16 v[96:111], v[160:163], v[168:171], v[96:111]
    ds_read_b64_tr_b16 v[20:21], v220 offset:27776
    ds_read_b64_tr_b16 v[22:23], v220 offset:28544
    ds_read_b64_tr_b16 v[28:29], v13 offset:4096
    s_waitcnt lgkmcnt(9)
    v_mfma_f32_32x32x16_bf16 v[112:127], v[160:163], v[172:175], v[112:127]
    ds_read_b64_tr_b16 v[30:31], v13 offset:5120
    ds_read_b64_tr_b16 v[32:33], v18 offset:4096
    ds_read_b64_tr_b16 v[34:35], v18 offset:5120
    s_waitcnt lgkmcnt(8)
    v_mfma_f32_32x32x16_bf16 v[96:111], v[176:179], v[184:187], v[96:111]
    ds_read_b64_tr_b16 v[40:41], v220 offset:30848
    ds_read_b64_tr_b16 v[42:43], v220 offset:31616
    ds_read_b64_tr_b16 v[48:49], v13 offset:8192
    s_nop 3
    s_waitcnt lgkmcnt(9)
    v_mfma_f32_32x32x16_bf16 v[112:127], v[176:179], v[188:191], v[112:127]
    ds_read_b64_tr_b16 v[50:51], v13 offset:9216
    ds_read_b64_tr_b16 v[52:53], v18 offset:8192
    ds_read_b64_tr_b16 v[54:55], v18 offset:9216
    v_max_f32 v96, 0, v96
    v_max_f32 v97, 0, v97
    v_max_f32 v98, 0, v98
    v_max_f32 v99, 0, v99
    s_waitcnt lgkmcnt(8)
    v_mfma_f32_32x32x16_bf16 v[128:143], v[20:23], v[28:31], v[128:143]
    ds_read_b64_tr_b16 v[160:161], v220 offset:33920
    ds_read_b64_tr_b16 v[162:163], v220 offset:34688
    ds_read_b64_tr_b16 v[168:169], v13 offset:12288
    v_max_f32 v100, 0, v100
    v_max_f32 v101, 0, v101
    v_max_f32 v102, 0, v102
    v_max_f32 v103, 0, v103
    s_waitcnt lgkmcnt(9)
    v_mfma_f32_32x32x16_bf16 v[144:159], v[20:23], v[32:35], v[144:159]
    ds_read_b64_tr_b16 v[170:171], v13 offset:13312
    ds_read_b64_tr_b16 v[172:173], v18 offset:12288
    ds_read_b64_tr_b16 v[174:175], v18 offset:13312
    v_mul_f32 v96, v96, v104
    v_mul_f32 v97, v97, v105
    v_mul_f32 v98, v98, v106
    v_mul_f32 v99, v99, v107
    s_waitcnt lgkmcnt(8)
    v_mfma_f32_32x32x16_bf16 v[128:143], v[40:43], v[48:51], v[128:143]
    ds_read_b64_tr_b16 v[176:177], v221 offset:64
    ds_read_b64_tr_b16 v[178:179], v221 offset:832
    ds_read_b64_tr_b16 v[184:185], v13 offset:16384
    v_mul_f32 v100, v100, v108
    v_mul_f32 v101, v101, v109
    v_mul_f32 v102, v102, v110
    v_mul_f32 v103, v103, v111
    s_waitcnt lgkmcnt(9)
    v_mfma_f32_32x32x16_bf16 v[144:159], v[40:43], v[52:55], v[144:159]
    ds_read_b64_tr_b16 v[186:187], v13 offset:17408
    ds_read_b64_tr_b16 v[188:189], v18 offset:16384
    ds_read_b64_tr_b16 v[190:191], v18 offset:17408
    v_cvt_pk_bf16_f32 v104, v96, v97
    v_cvt_pk_bf16_f32 v105, v98, v99
    v_cvt_pk_bf16_f32 v106, v100, v101
    v_cvt_pk_bf16_f32 v107, v102, v103
    s_waitcnt lgkmcnt(8)
    v_mfma_f32_32x32x16_bf16 v[128:143], v[160:163], v[168:171], v[128:143]
    ds_read_b64_tr_b16 v[20:21], v221 offset:3136
    ds_read_b64_tr_b16 v[22:23], v221 offset:3904
    ds_read_b64_tr_b16 v[28:29], v13 offset:20480
    s_add_u32 s15, s17, 29696
    buffer_store_dwordx4 v[104:107], v11, s[40:43], s15 offen sc1
    v_max_f32 v112, 0, v112
    v_max_f32 v113, 0, v113
    v_max_f32 v114, 0, v114
    s_waitcnt lgkmcnt(9)
    v_mfma_f32_32x32x16_bf16 v[144:159], v[160:163], v[172:175], v[144:159]
    ds_read_b64_tr_b16 v[30:31], v13 offset:21504
    ds_read_b64_tr_b16 v[32:33], v18 offset:20480
    ds_read_b64_tr_b16 v[34:35], v18 offset:21504
    v_max_f32 v115, 0, v115
    v_max_f32 v116, 0, v116
    v_max_f32 v117, 0, v117
    v_max_f32 v118, 0, v118
    s_waitcnt lgkmcnt(8)
    v_mfma_f32_32x32x16_bf16 v[128:143], v[176:179], v[184:187], v[128:143]
    ds_read_b64_tr_b16 v[40:41], v221 offset:6208
    ds_read_b64_tr_b16 v[42:43], v221 offset:6976
    ds_read_b64_tr_b16 v[48:49], v13 offset:24576
    ds_read_b64_tr_b16 v[50:51], v13 offset:25600
    ds_read_b64_tr_b16 v[52:53], v18 offset:24576
    v_max_f32 v119, 0, v119
    v_mul_f32 v112, v112, v120
    s_waitcnt lgkmcnt(11)
    v_mfma_f32_32x32x16_bf16 v[144:159], v[176:179], v[188:191], v[144:159]
    ds_read_b64_tr_b16 v[54:55], v18 offset:25600
    v_mul_f32 v113, v113, v121
    v_mul_f32 v114, v114, v122
    v_mul_f32 v115, v115, v123
    v_mul_f32 v116, v116, v124
    v_mul_f32 v117, v117, v125
    v_mul_f32 v118, v118, v126
    s_waitcnt lgkmcnt(8)
    v_mfma_f32_32x32x16_bf16 v[128:143], v[20:23], v[28:31], v[128:143]
    ds_read_b64_tr_b16 v[160:161], v221 offset:9280
    ds_read_b64_tr_b16 v[162:163], v221 offset:10048
    ds_read_b64_tr_b16 v[168:169], v13 offset:28672
    ds_read_b64_tr_b16 v[170:171], v13 offset:29696
    ds_read_b64_tr_b16 v[172:173], v18 offset:28672
    v_mul_f32 v119, v119, v127
    v_cvt_pk_bf16_f32 v120, v112, v113
    s_waitcnt lgkmcnt(11)
    v_mfma_f32_32x32x16_bf16 v[144:159], v[20:23], v[32:35], v[144:159]
    ds_read_b64_tr_b16 v[174:175], v18 offset:29696
    v_cvt_pk_bf16_f32 v121, v114, v115
    v_cvt_pk_bf16_f32 v122, v116, v117
    v_cvt_pk_bf16_f32 v123, v118, v119
    s_add_u32 s15, s18, 29696
    buffer_store_dwordx4 v[120:123], v11, s[40:43], s15 offen sc1
    s_waitcnt lgkmcnt(8)
    v_mfma_f32_32x32x16_bf16 v[128:143], v[40:43], v[48:51], v[128:143]
    s_waitcnt lgkmcnt(0)
    ds_read_b64_tr_b16 v[64:65], v246 offset:0
    ds_read_b64_tr_b16 v[66:67], v246 offset:1024
    ds_read_b64_tr_b16 v[68:69], v247 offset:0
    ds_read_b64_tr_b16 v[70:71], v247 offset:1024
    ds_read_b64_tr_b16 v[72:73], v246 offset:2048
    ds_read_b64_tr_b16 v[74:75], v246 offset:3072
    ds_read_b64_tr_b16 v[76:77], v247 offset:2048
    ds_read_b64_tr_b16 v[78:79], v247 offset:3072
    ds_read_b64_tr_b16 v[80:81], v246 offset:4096
    ds_read_b64_tr_b16 v[82:83], v246 offset:5120
    ds_read_b64_tr_b16 v[84:85], v247 offset:4096
    ds_read_b64_tr_b16 v[86:87], v247 offset:5120
    ds_read_b64_tr_b16 v[88:89], v246 offset:6144
    ds_read_b64_tr_b16 v[90:91], v246 offset:7168
    ds_read_b64_tr_b16 v[92:93], v247 offset:6144
    ds_read_b64_tr_b16 v[94:95], v247 offset:7168
    s_barrier
    s_waitcnt vmcnt(2)
    s_mov_b64 exec, 1
    buffer_atomic_add v248, v253, s[40:43], 0 offen offset:0 sc1
    s_mov_b64 exec, -1
    v_mfma_f32_32x32x16_bf16 v[144:159], v[40:43], v[52:55], v[144:159]
    v_mfma_f32_32x32x16_bf16 v[128:143], v[160:163], v[168:171], v[128:143]
    s_nop 6
    v_mfma_f32_32x32x16_bf16 v[144:159], v[160:163], v[172:175], v[144:159]
    s_nop 3
    v_max_f32 v128, 0, v128
    v_max_f32 v129, 0, v129
    v_max_f32 v130, 0, v130
    v_max_f32 v131, 0, v131
    v_max_f32 v132, 0, v132
    v_max_f32 v133, 0, v133
    v_max_f32 v134, 0, v134
    v_max_f32 v135, 0, v135
    v_mul_f32 v128, v128, v136
    v_mul_f32 v129, v129, v137
    v_mul_f32 v130, v130, v138
    v_mul_f32 v131, v131, v139
    v_mul_f32 v132, v132, v140
    v_mul_f32 v133, v133, v141
    v_mul_f32 v134, v134, v142
    v_mul_f32 v135, v135, v143
    v_cvt_pk_bf16_f32 v136, v128, v129
    v_cvt_pk_bf16_f32 v137, v130, v131
    v_cvt_pk_bf16_f32 v138, v132, v133
    v_cvt_pk_bf16_f32 v139, v134, v135
    s_add_u32 s15, s17, 59392
    buffer_store_dwordx4 v[136:139], v11, s[40:43], s15 offen sc1
    v_max_f32 v144, 0, v144
    v_max_f32 v145, 0, v145
    v_max_f32 v146, 0, v146
    v_max_f32 v147, 0, v147
    v_max_f32 v148, 0, v148
    v_max_f32 v149, 0, v149
    v_max_f32 v150, 0, v150
    v_max_f32 v151, 0, v151
    v_mul_f32 v144, v144, v152
    v_mul_f32 v145, v145, v153
    v_mul_f32 v146, v146, v154
    v_mul_f32 v147, v147, v155
    v_mul_f32 v148, v148, v156
    v_mul_f32 v149, v149, v157
    v_mul_f32 v150, v150, v158
    v_mul_f32 v151, v151, v159
    v_cvt_pk_bf16_f32 v152, v144, v145
    v_cvt_pk_bf16_f32 v153, v146, v147
    v_cvt_pk_bf16_f32 v154, v148, v149
    v_cvt_pk_bf16_f32 v155, v150, v151
    s_add_u32 s15, s18, 59392
    buffer_store_dwordx4 v[152:155], v11, s[40:43], s15 offen sc1
    s_waitcnt vmcnt(3)
    s_mov_b64 exec, 1
    buffer_atomic_add v248, v253, s[40:43], 0 offen offset:128 sc1
    s_mov_b64 exec, -1
    s_waitcnt lgkmcnt(0)
    s_branch L_c_p4b
L_c_p4:
    ds_read_b64_tr_b16 v[64:65], v246 offset:0
    ds_read_b64_tr_b16 v[66:67], v246 offset:1024
    ds_read_b64_tr_b16 v[68:69], v247 offset:0
    ds_read_b64_tr_b16 v[70:71], v247 offset:1024
    ds_read_b64_tr_b16 v[72:73], v246 offset:2048
    ds_read_b64_tr_b16 v[74:75], v246 offset:3072
    ds_read_b64_tr_b16 v[76:77], v247 offset:2048
    ds_read_b64_tr_b16 v[78:79], v247 offset:3072
    ds_read_b64_tr_b16 v[80:81], v246 offset:4096
    ds_read_b64_tr_b16 v[82:83], v246 offset:5120
    ds_read_b64_tr_b16 v[84:85], v247 offset:4096
    ds_read_b64_tr_b16 v[86:87], v247 offset:5120
    ds_read_b64_tr_b16 v[88:89], v246 offset:6144
    ds_read_b64_tr_b16 v[90:91], v246 offset:7168
    ds_read_b64_tr_b16 v[92:93], v247 offset:6144
    ds_read_b64_tr_b16 v[94:95], v247 offset:7168
    s_waitcnt lgkmcnt(0)
    s_barrier
L_c_p4b:
    s_lshl_b32 s25, s77, 1
    s_add_u32 s25, s25, s20
    s_mul_i32 s25, s25, 98304
    s_lshl_b32 s16, s21, 12
    s_add_u32 s25, s25, s16
    s_add_u32 s25, s25, 0x710000
    s_lshl_b32 s27, s28, 7
    s_lshl_b32 s15, s21, 6
    s_add_u32 s27, s27, s15
    v_add_u32 v52, 0x10000, v246
    v_add_u32 v53, 0x10000, v247
    v_add_u32 v54, 0x20000, v246
    v_add_u32 v55, 0x20000, v247
    s_lshl_b32 s30, s13, 17
    s_lshl_b32 s16, s28, 14
    s_add_u32 s30, s30, s16
    s_lshl_b32 s16, s21, 13
    s_add_u32 s30, s30, s16
    s_add_u32 s30, s30, 0x510000
    s_add_u32 s31, s30, 4096
    buffer_load_short_d16_hi v224, v241, s[40:43], s30 offen offset:0 sc1
    buffer_load_short_d16_hi v225, v242, s[40:43], s30 offen offset:256 sc1
    buffer_load_short_d16_hi v226, v243, s[40:43], s30 offen offset:512 sc1
    buffer_load_short_d16_hi v227, v244, s[40:43], s30 offen offset:768 sc1
    buffer_load_short_d16_hi v228, v241, s[40:43], s30 offen offset:2048 sc1
    buffer_load_short_d16_hi v229, v242, s[40:43], s30 offen offset:2304 sc1
    buffer_load_short_d16_hi v230, v243, s[40:43], s30 offen offset:2560 sc1
    buffer_load_short_d16_hi v231, v244, s[40:43], s30 offen offset:2816 sc1
    buffer_load_short_d16_hi v232, v241, s[40:43], s31 offen offset:0 sc1
    buffer_load_short_d16_hi v233, v242, s[40:43], s31 offen offset:256 sc1
    buffer_load_short_d16_hi v234, v243, s[40:43], s31 offen offset:512 sc1
    buffer_load_short_d16_hi v235, v244, s[40:43], s31 offen offset:768 sc1
    buffer_load_short_d16_hi v236, v241, s[40:43], s31 offen offset:2048 sc1
    buffer_load_short_d16_hi v237, v242, s[40:43], s31 offen offset:2304 sc1
    buffer_load_short_d16_hi v238, v243, s[40:43], s31 offen offset:2560 sc1
    buffer_load_short_d16_hi v239, v244, s[40:43], s31 offen offset:2816 sc1
    s_waitcnt vmcnt(16)
    s_mov_b64 exec, 1
    buffer_atomic_add v248, v253, s[40:43], 0 offen offset:256 sc1
    s_mov_b64 exec, -1
    s_barrier
    s_add_u32 s17, s25, 0
    buffer_load_dwordx4 v[96:99], v11, s[40:43], s17 offen offset:0 sc1
    buffer_load_dwordx4 v[100:103], v11, s[40:43], s17 offen offset:1024 sc1
    buffer_load_dwordx4 v[104:107], v11, s[40:43], s17 offen offset:2048 sc1
    buffer_load_dwordx4 v[108:111], v11, s[40:43], s17 offen offset:3072 sc1
    s_add_u32 s17, s25, 8192
    buffer_load_dwordx4 v[112:115], v11, s[40:43], s17 offen offset:0 sc1
    buffer_load_dwordx4 v[116:119], v11, s[40:43], s17 offen offset:1024 sc1
    buffer_load_dwordx4 v[120:123], v11, s[40:43], s17 offen offset:2048 sc1
    buffer_load_dwordx4 v[124:127], v11, s[40:43], s17 offen offset:3072 sc1
    s_add_u32 s17, s25, 16384
    buffer_load_dwordx4 v[128:131], v11, s[40:43], s17 offen offset:0 sc1
    buffer_load_dwordx4 v[132:135], v11, s[40:43], s17 offen offset:1024 sc1
    buffer_load_dwordx4 v[136:139], v11, s[40:43], s17 offen offset:2048 sc1
    buffer_load_dwordx4 v[140:143], v11, s[40:43], s17 offen offset:3072 sc1
    s_waitcnt vmcnt(11)
    v_mfma_f32_32x32x16_bf16 v[160:175], v[64:67], v[96:99], 0
    ds_read_b64_tr_b16 v[192:193], v246 offset:16384
    ds_read_b64_tr_b16 v[194:195], v246 offset:17408
    v_mfma_f32_32x32x16_bf16 v[176:191], v[68:71], v[96:99], 0
    ds_read_b64_tr_b16 v[196:197], v247 offset:16384
    ds_read_b64_tr_b16 v[198:199], v247 offset:17408
    s_waitcnt vmcnt(10)
    v_mfma_f32_32x32x16_bf16 v[160:175], v[72:75], v[100:103], v[160:175]
    ds_read_b64_tr_b16 v[200:201], v246 offset:18432
    ds_read_b64_tr_b16 v[202:203], v246 offset:19456
    v_mfma_f32_32x32x16_bf16 v[176:191], v[76:79], v[100:103], v[176:191]
    ds_read_b64_tr_b16 v[204:205], v247 offset:18432
    ds_read_b64_tr_b16 v[206:207], v247 offset:19456
    s_barrier
    s_waitcnt vmcnt(9)
    v_mfma_f32_32x32x16_bf16 v[160:175], v[80:83], v[104:107], v[160:175]
    ds_read_b64_tr_b16 v[64:65], v246 offset:20480
    ds_read_b64_tr_b16 v[66:67], v246 offset:21504
    s_add_u32 s17, s25, 24576
    buffer_load_dwordx4 v[144:147], v11, s[40:43], s17 offen offset:0 sc1
    v_mfma_f32_32x32x16_bf16 v[176:191], v[84:87], v[104:107], v[176:191]
    ds_read_b64_tr_b16 v[68:69], v247 offset:20480
    ds_read_b64_tr_b16 v[70:71], v247 offset:21504
    buffer_load_dwordx4 v[148:151], v11, s[40:43], s17 offen offset:1024 sc1
    s_waitcnt vmcnt(10)
    v_mfma_f32_32x32x16_bf16 v[160:175], v[88:91], v[108:111], v[160:175]
    ds_read_b64_tr_b16 v[72:73], v246 offset:22528
    ds_read_b64_tr_b16 v[74:75], v246 offset:23552
    buffer_load_dwordx4 v[152:155], v11, s[40:43], s17 offen offset:2048 sc1
    v_mfma_f32_32x32x16_bf16 v[176:191], v[92:95], v[108:111], v[176:191]
    ds_read_b64_tr_b16 v[76:77], v247 offset:22528
    ds_read_b64_tr_b16 v[78:79], v247 offset:23552
    buffer_load_dwordx4 v[156:159], v11, s[40:43], s17 offen offset:3072 sc1
    s_waitcnt vmcnt(11)
    s_waitcnt lgkmcnt(14)
    v_mfma_f32_32x32x16_bf16 v[160:175], v[192:195], v[112:115], v[160:175]
    ds_read_b64_tr_b16 v[80:81], v246 offset:32768
    ds_read_b64_tr_b16 v[82:83], v246 offset:33792
    s_add_u32 s17, s25, 32768
    buffer_load_dwordx4 v[96:99], v11, s[40:43], s17 offen offset:0 sc1
    s_waitcnt lgkmcnt(14)
    v_mfma_f32_32x32x16_bf16 v[176:191], v[196:199], v[112:115], v[176:191]
    ds_read_b64_tr_b16 v[84:85], v247 offset:32768
    ds_read_b64_tr_b16 v[86:87], v247 offset:33792
    s_waitcnt vmcnt(11)
    s_waitcnt lgkmcnt(14)
    v_mfma_f32_32x32x16_bf16 v[160:175], v[200:203], v[116:119], v[160:175]
    ds_read_b64_tr_b16 v[88:89], v246 offset:34816
    ds_read_b64_tr_b16 v[90:91], v246 offset:35840
    buffer_load_dwordx4 v[100:103], v11, s[40:43], s17 offen offset:1024 sc1
    s_waitcnt lgkmcnt(14)
    v_mfma_f32_32x32x16_bf16 v[176:191], v[204:207], v[116:119], v[176:191]
    ds_read_b64_tr_b16 v[92:93], v247 offset:34816
    ds_read_b64_tr_b16 v[94:95], v247 offset:35840
    s_waitcnt vmcnt(11)
    s_waitcnt lgkmcnt(14)
    v_mfma_f32_32x32x16_bf16 v[160:175], v[64:67], v[120:123], v[160:175]
    ds_read_b64_tr_b16 v[192:193], v246 offset:36864
    ds_read_b64_tr_b16 v[194:195], v246 offset:37888
    buffer_load_dwordx4 v[104:107], v11, s[40:43], s17 offen offset:2048 sc1
    s_waitcnt lgkmcnt(14)
    v_mfma_f32_32x32x16_bf16 v[176:191], v[68:71], v[120:123], v[176:191]
    ds_read_b64_tr_b16 v[196:197], v247 offset:36864
    ds_read_b64_tr_b16 v[198:199], v247 offset:37888
    s_waitcnt vmcnt(11)
    s_waitcnt lgkmcnt(14)
    v_mfma_f32_32x32x16_bf16 v[160:175], v[72:75], v[124:127], v[160:175]
    ds_read_b64_tr_b16 v[200:201], v246 offset:38912
    ds_read_b64_tr_b16 v[202:203], v246 offset:39936
    buffer_load_dwordx4 v[108:111], v11, s[40:43], s17 offen offset:3072 sc1
    s_waitcnt lgkmcnt(14)
    v_mfma_f32_32x32x16_bf16 v[176:191], v[76:79], v[124:127], v[176:191]
    ds_read_b64_tr_b16 v[204:205], v247 offset:38912
    ds_read_b64_tr_b16 v[206:207], v247 offset:39936
    s_waitcnt vmcnt(11)
    s_waitcnt lgkmcnt(14)
    v_mfma_f32_32x32x16_bf16 v[160:175], v[80:83], v[128:131], v[160:175]
    ds_read_b64_tr_b16 v[64:65], v246 offset:49152
    ds_read_b64_tr_b16 v[66:67], v246 offset:50176
    s_add_u32 s17, s25, 40960
    buffer_load_dwordx4 v[112:115], v11, s[40:43], s17 offen offset:0 sc1
    s_waitcnt lgkmcnt(14)
    v_mfma_f32_32x32x16_bf16 v[176:191], v[84:87], v[128:131], v[176:191]
    ds_read_b64_tr_b16 v[68:69], v247 offset:49152
    ds_read_b64_tr_b16 v[70:71], v247 offset:50176
    s_waitcnt vmcnt(11)
    s_waitcnt lgkmcnt(14)
    v_mfma_f32_32x32x16_bf16 v[160:175], v[88:91], v[132:135], v[160:175]
    ds_read_b64_tr_b16 v[72:73], v246 offset:51200
    ds_read_b64_tr_b16 v[74:75], v246 offset:52224
    buffer_load_dwordx4 v[116:119], v11, s[40:43], s17 offen offset:1024 sc1
    s_waitcnt lgkmcnt(14)
    v_mfma_f32_32x32x16_bf16 v[176:191], v[92:95], v[132:135], v[176:191]
    ds_read_b64_tr_b16 v[76:77], v247 offset:51200
    ds_read_b64_tr_b16 v[78:79], v247 offset:52224
    s_waitcnt vmcnt(11)
    s_waitcnt lgkmcnt(14)
    v_mfma_f32_32x32x16_bf16 v[160:175], v[192:195], v[136:139], v[160:175]
    ds_read_b64_tr_b16 v[80:81], v246 offset:53248
    ds_read_b64_tr_b16 v[82:83], v246 offset:54272
    buffer_load_dwordx4 v[120:123], v11, s[40:43], s17 offen offset:2048 sc1
    s_waitcnt lgkmcnt(14)
    v_mfma_f32_32x32x16_bf16 v[176:191], v[196:199], v[136:139], v[176:191]
    ds_read_b64_tr_b16 v[84:85], v247 offset:53248
    ds_read_b64_tr_b16 v[86:87], v247 offset:54272
    s_waitcnt vmcnt(11)
    s_waitcnt lgkmcnt(14)
    v_mfma_f32_32x32x16_bf16 v[160:175], v[200:203], v[140:143], v[160:175]
    ds_read_b64_tr_b16 v[88:89], v246 offset:55296
    ds_read_b64_tr_b16 v[90:91], v246 offset:56320
    buffer_load_dwordx4 v[124:127], v11, s[40:43], s17 offen offset:3072 sc1
    s_waitcnt lgkmcnt(14)
    v_mfma_f32_32x32x16_bf16 v[176:191], v[204:207], v[140:143], v[176:191]
    ds_read_b64_tr_b16 v[92:93], v247 offset:55296
    ds_read_b64_tr_b16 v[94:95], v247 offset:56320
    s_waitcnt vmcnt(11)
    s_waitcnt lgkmcnt(14)
    v_mfma_f32_32x32x16_bf16 v[160:175], v[64:67], v[144:147], v[160:175]
    ds_read_b64_tr_b16 v[192:193], v52 offset:0
    ds_read_b64_tr_b16 v[194:195], v52 offset:1024
    s_add_u32 s17, s25, 49152
    buffer_load_dwordx4 v[128:131], v11, s[40:43], s17 offen offset:0 sc1
    s_waitcnt lgkmcnt(14)
    v_mfma_f32_32x32x16_bf16 v[176:191], v[68:71], v[144:147], v[176:191]
    ds_read_b64_tr_b16 v[196:197], v53 offset:0
    ds_read_b64_tr_b16 v[198:199], v53 offset:1024
    s_waitcnt vmcnt(11)
    s_waitcnt lgkmcnt(14)
    v_mfma_f32_32x32x16_bf16 v[160:175], v[72:75], v[148:151], v[160:175]
    ds_read_b64_tr_b16 v[200:201], v52 offset:2048
    ds_read_b64_tr_b16 v[202:203], v52 offset:3072
    buffer_load_dwordx4 v[132:135], v11, s[40:43], s17 offen offset:1024 sc1
    s_waitcnt lgkmcnt(14)
    v_mfma_f32_32x32x16_bf16 v[176:191], v[76:79], v[148:151], v[176:191]
    ds_read_b64_tr_b16 v[204:205], v53 offset:2048
    ds_read_b64_tr_b16 v[206:207], v53 offset:3072
    s_waitcnt vmcnt(11)
    s_waitcnt lgkmcnt(14)
    v_mfma_f32_32x32x16_bf16 v[160:175], v[80:83], v[152:155], v[160:175]
    ds_read_b64_tr_b16 v[64:65], v52 offset:4096
    ds_read_b64_tr_b16 v[66:67], v52 offset:5120
    buffer_load_dwordx4 v[136:139], v11, s[40:43], s17 offen offset:2048 sc1
    s_waitcnt lgkmcnt(14)
    v_mfma_f32_32x32x16_bf16 v[176:191], v[84:87], v[152:155], v[176:191]
    ds_read_b64_tr_b16 v[68:69], v53 offset:4096
    ds_read_b64_tr_b16 v[70:71], v53 offset:5120
    s_waitcnt vmcnt(11)
    s_waitcnt lgkmcnt(14)
    v_mfma_f32_32x32x16_bf16 v[160:175], v[88:91], v[156:159], v[160:175]
    ds_read_b64_tr_b16 v[72:73], v52 offset:6144
    ds_read_b64_tr_b16 v[74:75], v52 offset:7168
    buffer_load_dwordx4 v[140:143], v11, s[40:43], s17 offen offset:3072 sc1
    s_waitcnt lgkmcnt(14)
    v_mfma_f32_32x32x16_bf16 v[176:191], v[92:95], v[156:159], v[176:191]
    ds_read_b64_tr_b16 v[76:77], v53 offset:6144
    ds_read_b64_tr_b16 v[78:79], v53 offset:7168
    s_barrier
    s_waitcnt vmcnt(11)
    s_waitcnt lgkmcnt(14)
    v_mfma_f32_32x32x16_bf16 v[160:175], v[192:195], v[96:99], v[160:175]
    ds_read_b64_tr_b16 v[80:81], v52 offset:16384
    ds_read_b64_tr_b16 v[82:83], v52 offset:17408
    s_add_u32 s17, s25, 57344
    buffer_load_dwordx4 v[144:147], v11, s[40:43], s17 offen offset:0 sc1
    s_waitcnt lgkmcnt(14)
    v_mfma_f32_32x32x16_bf16 v[176:191], v[196:199], v[96:99], v[176:191]
    ds_read_b64_tr_b16 v[84:85], v53 offset:16384
    ds_read_b64_tr_b16 v[86:87], v53 offset:17408
    s_waitcnt vmcnt(11)
    s_waitcnt lgkmcnt(14)
    v_mfma_f32_32x32x16_bf16 v[160:175], v[200:203], v[100:103], v[160:175]
    ds_read_b64_tr_b16 v[88:89], v52 offset:18432
    ds_read_b64_tr_b16 v[90:91], v52 offset:19456
    buffer_load_dwordx4 v[148:151], v11, s[40:43], s17 offen offset:1024 sc1
    s_waitcnt lgkmcnt(14)
    v_mfma_f32_32x32x16_bf16 v[176:191], v[204:207], v[100:103], v[176:191]
    ds_read_b64_tr_b16 v[92:93], v53 offset:18432
    ds_read_b64_tr_b16 v[94:95], v53 offset:19456
    s_waitcnt vmcnt(11)
    s_waitcnt lgkmcnt(14)
    v_mfma_f32_32x32x16_bf16 v[160:175], v[64:67], v[104:107], v[160:175]
    ds_read_b64_tr_b16 v[192:193], v52 offset:20480
    ds_read_b64_tr_b16 v[194:195], v52 offset:21504
    buffer_load_dwordx4 v[152:155], v11, s[40:43], s17 offen offset:2048 sc1
    s_waitcnt lgkmcnt(14)
    v_mfma_f32_32x32x16_bf16 v[176:191], v[68:71], v[104:107], v[176:191]
    ds_read_b64_tr_b16 v[196:197], v53 offset:20480
    ds_read_b64_tr_b16 v[198:199], v53 offset:21504
    s_waitcnt vmcnt(11)
    s_waitcnt lgkmcnt(14)
    v_mfma_f32_32x32x16_bf16 v[160:175], v[72:75], v[108:111], v[160:175]
    ds_read_b64_tr_b16 v[200:201], v52 offset:22528
    ds_read_b64_tr_b16 v[202:203], v52 offset:23552
    buffer_load_dwordx4 v[156:159], v11, s[40:43], s17 offen offset:3072 sc1
    s_waitcnt lgkmcnt(14)
    v_mfma_f32_32x32x16_bf16 v[176:191], v[76:79], v[108:111], v[176:191]
    ds_read_b64_tr_b16 v[204:205], v53 offset:22528
    ds_read_b64_tr_b16 v[206:207], v53 offset:23552
    s_waitcnt vmcnt(11)
    s_waitcnt lgkmcnt(14)
    v_mfma_f32_32x32x16_bf16 v[160:175], v[80:83], v[112:115], v[160:175]
    ds_read_b64_tr_b16 v[64:65], v52 offset:32768
    ds_read_b64_tr_b16 v[66:67], v52 offset:33792
    s_add_u32 s17, s25, 65536
    buffer_load_dwordx4 v[96:99], v11, s[40:43], s17 offen offset:0 sc1
    s_waitcnt lgkmcnt(14)
    v_mfma_f32_32x32x16_bf16 v[176:191], v[84:87], v[112:115], v[176:191]
    ds_read_b64_tr_b16 v[68:69], v53 offset:32768
    ds_read_b64_tr_b16 v[70:71], v53 offset:33792
    s_waitcnt vmcnt(11)
    s_waitcnt lgkmcnt(14)
    v_mfma_f32_32x32x16_bf16 v[160:175], v[88:91], v[116:119], v[160:175]
    ds_read_b64_tr_b16 v[72:73], v52 offset:34816
    ds_read_b64_tr_b16 v[74:75], v52 offset:35840
    buffer_load_dwordx4 v[100:103], v11, s[40:43], s17 offen offset:1024 sc1
    s_waitcnt lgkmcnt(14)
    v_mfma_f32_32x32x16_bf16 v[176:191], v[92:95], v[116:119], v[176:191]
    ds_read_b64_tr_b16 v[76:77], v53 offset:34816
    ds_read_b64_tr_b16 v[78:79], v53 offset:35840
    s_waitcnt vmcnt(11)
    s_waitcnt lgkmcnt(14)
    v_mfma_f32_32x32x16_bf16 v[160:175], v[192:195], v[120:123], v[160:175]
    ds_read_b64_tr_b16 v[80:81], v52 offset:36864
    ds_read_b64_tr_b16 v[82:83], v52 offset:37888
    buffer_load_dwordx4 v[104:107], v11, s[40:43], s17 offen offset:2048 sc1
    s_waitcnt lgkmcnt(14)
    v_mfma_f32_32x32x16_bf16 v[176:191], v[196:199], v[120:123], v[176:191]
    ds_read_b64_tr_b16 v[84:85], v53 offset:36864
    ds_read_b64_tr_b16 v[86:87], v53 offset:37888
    s_waitcnt vmcnt(11)
    s_waitcnt lgkmcnt(14)
    v_mfma_f32_32x32x16_bf16 v[160:175], v[200:203], v[124:127], v[160:175]
    ds_read_b64_tr_b16 v[88:89], v52 offset:38912
    ds_read_b64_tr_b16 v[90:91], v52 offset:39936
    buffer_load_dwordx4 v[108:111], v11, s[40:43], s17 offen offset:3072 sc1
    s_waitcnt lgkmcnt(14)
    v_mfma_f32_32x32x16_bf16 v[176:191], v[204:207], v[124:127], v[176:191]
    ds_read_b64_tr_b16 v[92:93], v53 offset:38912
    ds_read_b64_tr_b16 v[94:95], v53 offset:39936
    s_waitcnt vmcnt(11)
    s_waitcnt lgkmcnt(14)
    v_mfma_f32_32x32x16_bf16 v[160:175], v[64:67], v[128:131], v[160:175]
    ds_read_b64_tr_b16 v[192:193], v52 offset:49152
    ds_read_b64_tr_b16 v[194:195], v52 offset:50176
    s_add_u32 s17, s25, 73728
    buffer_load_dwordx4 v[112:115], v11, s[40:43], s17 offen offset:0 sc1
    s_waitcnt lgkmcnt(14)
    v_mfma_f32_32x32x16_bf16 v[176:191], v[68:71], v[128:131], v[176:191]
    ds_read_b64_tr_b16 v[196:197], v53 offset:49152
    ds_read_b64_tr_b16 v[198:199], v53 offset:50176
    s_waitcnt vmcnt(11)
    s_waitcnt lgkmcnt(14)
    v_mfma_f32_32x32x16_bf16 v[160:175], v[72:75], v[132:135], v[160:175]
    ds_read_b64_tr_b16 v[200:201], v52 offset:51200
    ds_read_b64_tr_b16 v[202:203], v52 offset:52224
    buffer_load_dwordx4 v[116:119], v11, s[40:43], s17 offen offset:1024 sc1
    s_waitcnt lgkmcnt(14)
    v_mfma_f32_32x32x16_bf16 v[176:191], v[76:79], v[132:135], v[176:191]
    ds_read_b64_tr_b16 v[204:205], v53 offset:51200
    ds_read_b64_tr_b16 v[206:207], v53 offset:52224
    s_waitcnt vmcnt(11)
    s_waitcnt lgkmcnt(14)
    v_mfma_f32_32x32x16_bf16 v[160:175], v[80:83], v[136:139], v[160:175]
    ds_read_b64_tr_b16 v[64:65], v52 offset:53248
    ds_read_b64_tr_b16 v[66:67], v52 offset:54272
    buffer_load_dwordx4 v[120:123], v11, s[40:43], s17 offen offset:2048 sc1
    s_waitcnt lgkmcnt(14)
    v_mfma_f32_32x32x16_bf16 v[176:191], v[84:87], v[136:139], v[176:191]
    ds_read_b64_tr_b16 v[68:69], v53 offset:53248
    ds_read_b64_tr_b16 v[70:71], v53 offset:54272
    s_waitcnt vmcnt(11)
    s_waitcnt lgkmcnt(14)
    v_mfma_f32_32x32x16_bf16 v[160:175], v[88:91], v[140:143], v[160:175]
    ds_read_b64_tr_b16 v[72:73], v52 offset:55296
    ds_read_b64_tr_b16 v[74:75], v52 offset:56320
    buffer_load_dwordx4 v[124:127], v11, s[40:43], s17 offen offset:3072 sc1
    s_waitcnt lgkmcnt(14)
    v_mfma_f32_32x32x16_bf16 v[176:191], v[92:95], v[140:143], v[176:191]
    ds_read_b64_tr_b16 v[76:77], v53 offset:55296
    ds_read_b64_tr_b16 v[78:79], v53 offset:56320
    s_waitcnt vmcnt(11)
    s_waitcnt lgkmcnt(14)
    v_mfma_f32_32x32x16_bf16 v[160:175], v[192:195], v[144:147], v[160:175]
    ds_read_b64_tr_b16 v[80:81], v54 offset:0
    ds_read_b64_tr_b16 v[82:83], v54 offset:1024
    s_add_u32 s17, s25, 81920
    buffer_load_dwordx4 v[128:131], v11, s[40:43], s17 offen offset:0 sc1
    s_waitcnt lgkmcnt(14)
    v_mfma_f32_32x32x16_bf16 v[176:191], v[196:199], v[144:147], v[176:191]
    ds_read_b64_tr_b16 v[84:85], v55 offset:0
    ds_read_b64_tr_b16 v[86:87], v55 offset:1024
    s_waitcnt vmcnt(11)
    s_waitcnt lgkmcnt(14)
    v_mfma_f32_32x32x16_bf16 v[160:175], v[200:203], v[148:151], v[160:175]
    ds_read_b64_tr_b16 v[88:89], v54 offset:2048
    ds_read_b64_tr_b16 v[90:91], v54 offset:3072
    buffer_load_dwordx4 v[132:135], v11, s[40:43], s17 offen offset:1024 sc1
    s_waitcnt lgkmcnt(14)
    v_mfma_f32_32x32x16_bf16 v[176:191], v[204:207], v[148:151], v[176:191]
    ds_read_b64_tr_b16 v[92:93], v55 offset:2048
    ds_read_b64_tr_b16 v[94:95], v55 offset:3072
    s_waitcnt vmcnt(11)
    s_waitcnt lgkmcnt(14)
    v_mfma_f32_32x32x16_bf16 v[160:175], v[64:67], v[152:155], v[160:175]
    ds_read_b64_tr_b16 v[192:193], v54 offset:4096
    ds_read_b64_tr_b16 v[194:195], v54 offset:5120
    buffer_load_dwordx4 v[136:139], v11, s[40:43], s17 offen offset:2048 sc1
    s_waitcnt lgkmcnt(14)
    v_mfma_f32_32x32x16_bf16 v[176:191], v[68:71], v[152:155], v[176:191]
    ds_read_b64_tr_b16 v[196:197], v55 offset:4096
    ds_read_b64_tr_b16 v[198:199], v55 offset:5120
    s_waitcnt vmcnt(11)
    s_waitcnt lgkmcnt(14)
    v_mfma_f32_32x32x16_bf16 v[160:175], v[72:75], v[156:159], v[160:175]
    ds_read_b64_tr_b16 v[200:201], v54 offset:6144
    ds_read_b64_tr_b16 v[202:203], v54 offset:7168
    buffer_load_dwordx4 v[140:143], v11, s[40:43], s17 offen offset:3072 sc1
    s_waitcnt lgkmcnt(14)
    v_mfma_f32_32x32x16_bf16 v[176:191], v[76:79], v[156:159], v[176:191]
    ds_read_b64_tr_b16 v[204:205], v55 offset:6144
    ds_read_b64_tr_b16 v[206:207], v55 offset:7168
    s_waitcnt vmcnt(11)
    s_waitcnt lgkmcnt(14)
    v_mfma_f32_32x32x16_bf16 v[160:175], v[80:83], v[96:99], v[160:175]
    ds_read_b64_tr_b16 v[64:65], v54 offset:16384
    ds_read_b64_tr_b16 v[66:67], v54 offset:17408
    s_waitcnt lgkmcnt(14)
    v_mfma_f32_32x32x16_bf16 v[176:191], v[84:87], v[96:99], v[176:191]
    ds_read_b64_tr_b16 v[68:69], v55 offset:16384
    ds_read_b64_tr_b16 v[70:71], v55 offset:17408
    s_waitcnt vmcnt(10)
    s_waitcnt lgkmcnt(14)
    v_mfma_f32_32x32x16_bf16 v[160:175], v[88:91], v[100:103], v[160:175]
    ds_read_b64_tr_b16 v[72:73], v54 offset:18432
    ds_read_b64_tr_b16 v[74:75], v54 offset:19456
    s_waitcnt lgkmcnt(14)
    v_mfma_f32_32x32x16_bf16 v[176:191], v[92:95], v[100:103], v[176:191]
    ds_read_b64_tr_b16 v[76:77], v55 offset:18432
    ds_read_b64_tr_b16 v[78:79], v55 offset:19456
    s_waitcnt vmcnt(9)
    s_waitcnt lgkmcnt(14)
    v_mfma_f32_32x32x16_bf16 v[160:175], v[192:195], v[104:107], v[160:175]
    ds_read_b64_tr_b16 v[80:81], v54 offset:20480
    ds_read_b64_tr_b16 v[82:83], v54 offset:21504
    s_waitcnt lgkmcnt(14)
    v_mfma_f32_32x32x16_bf16 v[176:191], v[196:199], v[104:107], v[176:191]
    ds_read_b64_tr_b16 v[84:85], v55 offset:20480
    ds_read_b64_tr_b16 v[86:87], v55 offset:21504
    s_waitcnt vmcnt(8)
    s_waitcnt lgkmcnt(14)
    v_mfma_f32_32x32x16_bf16 v[160:175], v[200:203], v[108:111], v[160:175]
    ds_read_b64_tr_b16 v[88:89], v54 offset:22528
    ds_read_b64_tr_b16 v[90:91], v54 offset:23552
    s_waitcnt lgkmcnt(14)
    v_mfma_f32_32x32x16_bf16 v[176:191], v[204:207], v[108:111], v[176:191]
    ds_read_b64_tr_b16 v[92:93], v55 offset:22528
    ds_read_b64_tr_b16 v[94:95], v55 offset:23552
    s_lshl_b32 s15, s13, 9
    s_add_u32 s15, s15, 0x460000
    buffer_load_dword v240, v62, s[40:43], s15 offen sc1
    s_waitcnt vmcnt(8)
    s_waitcnt lgkmcnt(14)
    v_mfma_f32_32x32x16_bf16 v[160:175], v[64:67], v[112:115], v[160:175]
    ds_read_b64_tr_b16 v[192:193], v246 offset:0
    ds_read_b64_tr_b16 v[194:195], v246 offset:1024
    s_waitcnt lgkmcnt(14)
    v_mfma_f32_32x32x16_bf16 v[176:191], v[68:71], v[112:115], v[176:191]
    ds_read_b64_tr_b16 v[196:197], v247 offset:0
    ds_read_b64_tr_b16 v[198:199], v247 offset:1024
    s_waitcnt vmcnt(7)
    s_waitcnt lgkmcnt(14)
    v_mfma_f32_32x32x16_bf16 v[160:175], v[72:75], v[116:119], v[160:175]
    ds_read_b64_tr_b16 v[200:201], v246 offset:2048
    ds_read_b64_tr_b16 v[202:203], v246 offset:3072
    s_waitcnt lgkmcnt(14)
    v_mfma_f32_32x32x16_bf16 v[176:191], v[76:79], v[116:119], v[176:191]
    ds_read_b64_tr_b16 v[204:205], v247 offset:2048
    ds_read_b64_tr_b16 v[206:207], v247 offset:3072
    s_waitcnt vmcnt(6)
    s_waitcnt lgkmcnt(14)
    v_mfma_f32_32x32x16_bf16 v[160:175], v[80:83], v[120:123], v[160:175]
    ds_read_b64_tr_b16 v[64:65], v246 offset:4096
    ds_read_b64_tr_b16 v[66:67], v246 offset:5120
    s_waitcnt lgkmcnt(14)
    v_mfma_f32_32x32x16_bf16 v[176:191], v[84:87], v[120:123], v[176:191]
    ds_read_b64_tr_b16 v[68:69], v247 offset:4096
    ds_read_b64_tr_b16 v[70:71], v247 offset:5120
    s_waitcnt vmcnt(5)
    s_waitcnt lgkmcnt(14)
    v_mfma_f32_32x32x16_bf16 v[160:175], v[88:91], v[124:127], v[160:175]
    ds_read_b64_tr_b16 v[72:73], v246 offset:6144
    ds_read_b64_tr_b16 v[74:75], v246 offset:7168
    s_waitcnt lgkmcnt(14)
    v_mfma_f32_32x32x16_bf16 v[176:191], v[92:95], v[124:127], v[176:191]
    ds_read_b64_tr_b16 v[76:77], v247 offset:6144
    ds_read_b64_tr_b16 v[78:79], v247 offset:7168
    s_lshl_b32 s15, s11, 12
    s_add_u32 s15, s15, 16384
    s_xor_b32 s16, s15, 4096
    v_add_u32 v56, s15, v11
    v_add_u32 v57, s16, v11
    s_lshl_b32 s15, s21, 2
    v_add_u32 v58, s15, v7
    v_and_b32 v59, 7, v2
    v_xor_b32 v58, v58, v59
    v_xor_b32 v60, 2, v58
    s_lshl_b32 s15, s20, 12
    s_add_u32 s15, s15, 32768
    v_lshlrev_b32 v63, 7, v9
    v_add_u32 v63, s15, v63
    v_lshl_add_u32 v58, v58, 4, v63
    v_lshl_add_u32 v60, v60, 4, v63
    v_lshrrev_b32 v63, 3, v2
    v_xor_b32 v242, v59, v63
    v_lshlrev_b32 v242, 4, v242
    v_lshl_add_u32 v242, v63, 7, v242
    s_lshl_b32 s15, s11, 11
    s_add_u32 s15, s15, 32768
    v_add_u32 v242, s15, v242
    v_lshlrev_b32 v243, 10, v63
    v_lshl_add_u32 v243, v59, 4, v243
    s_lshl_b32 s27, s77, 16
    s_lshl_b32 s15, s11, 14
    s_add_u32 s27, s27, s15
    s_lshl_b32 s15, s28, 7
    s_add_u32 s27, s27, s15
    s_add_u32 s26, s27, 8192
    s_waitcnt vmcnt(4)
    s_waitcnt lgkmcnt(12)
    v_mfma_f32_32x32x16_bf16 v[176:191], v[196:199], v[128:131], v[176:191]
    s_waitcnt vmcnt(3)
    s_waitcnt lgkmcnt(8)
    v_mfma_f32_32x32x16_bf16 v[176:191], v[204:207], v[132:135], v[176:191]
    s_waitcnt vmcnt(2)
    s_waitcnt lgkmcnt(4)
    v_mfma_f32_32x32x16_bf16 v[176:191], v[68:71], v[136:139], v[176:191]
    s_waitcnt vmcnt(1)
    s_waitcnt lgkmcnt(0)
    v_mfma_f32_32x32x16_bf16 v[176:191], v[76:79], v[140:143], v[176:191]
    v_mfma_f32_32x32x16_bf16 v[160:175], v[192:195], v[128:131], v[160:175]
    s_nop 5
    v_mfma_f32_32x32x16_bf16 v[160:175], v[200:203], v[132:135], v[160:175]
    s_nop 5
    v_mfma_f32_32x32x16_bf16 v[160:175], v[64:67], v[136:139], v[160:175]
    ds_write_b128 v56, v[176:179] offset:0
    ds_write_b128 v56, v[180:183] offset:1024
    v_mfma_f32_32x32x16_bf16 v[160:175], v[72:75], v[140:143], v[160:175]
    ds_write_b128 v56, v[184:187] offset:2048
    ds_write_b128 v56, v[188:191] offset:3072
    s_waitcnt vmcnt(0) lgkmcnt(0)
    s_barrier
    ds_read_b128 v[64:67], v57 offset:0
    ds_read_b128 v[68:71], v57 offset:1024
    ds_read_b128 v[72:75], v57 offset:2048
    ds_read_b128 v[76:79], v57 offset:3072
    v_mov_b32 v241, v240
    s_nop 5
    s_waitcnt lgkmcnt(3)
    v_pk_add_f32 v[160:161], v[160:161], v[64:65]
    v_pk_add_f32 v[162:163], v[162:163], v[66:67]
    v_pk_fma_f32 v[160:161], v[160:161], v[240:241], v[224:225]
    v_pk_fma_f32 v[162:163], v[162:163], v[240:241], v[226:227]
    v_cvt_pk_bf16_f32 v32, v160, v161
    v_cvt_pk_bf16_f32 v33, v162, v163
    s_waitcnt lgkmcnt(2)
    v_pk_add_f32 v[164:165], v[164:165], v[68:69]
    v_pk_add_f32 v[166:167], v[166:167], v[70:71]
    v_pk_fma_f32 v[164:165], v[164:165], v[240:241], v[228:229]
    v_pk_fma_f32 v[166:167], v[166:167], v[240:241], v[230:231]
    v_cvt_pk_bf16_f32 v34, v164, v165
    v_cvt_pk_bf16_f32 v35, v166, v167
    s_nop 1
    v_permlane32_swap_b32 v32, v34
    v_permlane32_swap_b32 v33, v35
    ds_write_b128 v58, v[32:35]
    s_waitcnt lgkmcnt(1)
    v_pk_add_f32 v[168:169], v[168:169], v[72:73]
    v_pk_add_f32 v[170:171], v[170:171], v[74:75]
    v_pk_fma_f32 v[168:169], v[168:169], v[240:241], v[232:233]
    v_pk_fma_f32 v[170:171], v[170:171], v[240:241], v[234:235]
    v_cvt_pk_bf16_f32 v36, v168, v169
    v_cvt_pk_bf16_f32 v37, v170, v171
    s_waitcnt lgkmcnt(0)
    v_pk_add_f32 v[172:173], v[172:173], v[76:77]
    v_pk_add_f32 v[174:175], v[174:175], v[78:79]
    v_pk_fma_f32 v[172:173], v[172:173], v[240:241], v[236:237]
    v_pk_fma_f32 v[174:175], v[174:175], v[240:241], v[238:239]
    v_cvt_pk_bf16_f32 v38, v172, v173
    v_cvt_pk_bf16_f32 v39, v174, v175
    s_nop 1
    v_permlane32_swap_b32 v36, v38
    v_permlane32_swap_b32 v37, v39
    ds_write_b128 v60, v[36:39]
    s_waitcnt lgkmcnt(0)
    s_barrier
    ds_read_b128 v[40:43], v242
    ds_read_b128 v[44:47], v242 offset:1024
    s_waitcnt lgkmcnt(1)
    buffer_store_dwordx4 v[40:43], v243, s[72:75], s27 offen sc1
    s_waitcnt lgkmcnt(0)
    buffer_store_dwordx4 v[44:47], v243, s[72:75], s26 offen sc1
    s_endpgm
L_H:
    v_lshlrev_b32 v4, 2, v2
    v_add_u32 v4, 163776, v4
    v_mov_b32 v5, 0
    s_mov_b64 exec, 0xffff
    ds_write_b32 v4, v5
    s_mov_b64 exec, -1
    v_lshlrev_b32 v11, 4, v2
    s_lshl_b32 s26, s31, 3
    s_add_u32 s26, s26, s30
    s_lshl_b32 s24, s26, 13
    s_lshl_b32 s16, s11, 11
    s_add_u32 s24, s24, s16
    buffer_load_dwordx4 v[56:59], v11, s[32:35], s24 offen nt
    buffer_load_dwordx4 v[60:63], v11, s[32:35], s24 offen offset:1024 nt
    v_lshrrev_b32 v12, 3, v2
    v_and_b32 v20, 7, v2
    v_bfe_u32 v21, v2, 4, 1
    v_lshlrev_b32 v21, 2, v21
    v_xor_b32 v20, v20, v21
    v_lshlrev_b32 v12, 10, v12
    v_lshl_add_u32 v12, v20, 4, v12
    s_mul_i32 s24, s11, 98304
    s_lshl_b32 s16, s28, 7
    s_add_u32 s24, s24, s16
    v_lshlrev_b32 v17, 7, v2
    v_add_u32 v20, 0, v2
    v_mul_u32_u24 v21, 0x5556, v20
    v_lshrrev_b32 v21, 18, v21
    v_mul_u32_u24 v22, 12, v21
    v_sub_u32 v22, v20, v22
    v_mul_u32_u24 v21, 2752, v21
    v_lshl_add_u32 v14, v22, 4, v21
    v_add_u32 v20, 64, v2
    v_mul_u32_u24 v21, 0x5556, v20
    v_lshrrev_b32 v21, 18, v21
    v_mul_u32_u24 v22, 12, v21
    v_sub_u32 v22, v20, v22
    v_mul_u32_u24 v21, 2752, v21
    v_lshl_add_u32 v15, v22, 4, v21
    v_subrev_u32 v15, 1024, v15
    v_add_u32 v20, 128, v2
    v_mul_u32_u24 v21, 0x5556, v20
    v_lshrrev_b32 v21, 18, v21
    v_mul_u32_u24 v22, 12, v21
    v_sub_u32 v22, v20, v22
    v_mul_u32_u24 v21, 2752, v21
    v_lshl_add_u32 v16, v22, 4, v21
    v_subrev_u32 v16, 2048, v16
    s_mul_i32 s22, s11, 44032
    s_mul_i32 s15, s7, 192
    s_add_u32 s22, s22, s15
    s_mul_i32 s23, s11, 3072
    s_mov_b32 s16, 0x05040100
    s_mov_b32 s17, 0x07060302
    s_waitcnt vmcnt(3)
    v_perm_b32 v92, v40, v38, s16
    v_perm_b32 v93, v44, v42, s16
    ds_write_b64 v13, v[92:93] offset:0
    v_perm_b32 v94, v40, v38, s17
    v_perm_b32 v95, v44, v42, s17
    ds_write_b64 v13, v[94:95] offset:128
    v_perm_b32 v96, v41, v39, s16
    v_perm_b32 v97, v45, v43, s16
    ds_write_b64 v13, v[96:97] offset:256
    v_perm_b32 v98, v41, v39, s17
    v_perm_b32 v99, v45, v43, s17
    ds_write_b64 v13, v[98:99] offset:384
    s_waitcnt lgkmcnt(0)
    s_barrier
    ds_read_b128 v[28:31], v124
    ds_read_b128 v[32:35], v125 offset:1024
    s_waitcnt lgkmcnt(1)
    buffer_store_dwordx4 v[28:31], v126, s[40:43], s18 offen sc1
    s_waitcnt lgkmcnt(0)
    buffer_store_dwordx4 v[32:35], v126, s[40:43], s19 offen sc1
    s_waitcnt vmcnt(2)
    v_add_u32 v254, 1, v254
    s_nop 0
    v_readfirstlane_b32 s9, v254
    v_lshlrev_b32 v64, 16, v56
    v_and_b32 v65, s14, v56
    v_lshlrev_b32 v66, 16, v57
    v_and_b32 v67, s14, v57
    v_lshlrev_b32 v68, 16, v58
    v_and_b32 v69, s14, v58
    v_lshlrev_b32 v70, 16, v59
    v_and_b32 v71, s14, v59
    v_lshlrev_b32 v72, 16, v60
    v_and_b32 v73, s14, v60
    v_lshlrev_b32 v74, 16, v61
    v_and_b32 v75, s14, v61
    v_lshlrev_b32 v76, 16, v62
    v_and_b32 v77, s14, v62
    v_lshlrev_b32 v78, 16, v63
    v_and_b32 v79, s14, v63
    v_add_f32 v100, v64, v65
    v_add_f32 v100, v100, v66
    v_add_f32 v100, v100, v67
    v_add_f32 v100, v100, v68
    v_add_f32 v100, v100, v69
    v_add_f32 v100, v100, v70
    v_add_f32 v100, v100, v71
    v_add_f32 v101, v72, v73
    v_add_f32 v101, v101, v74
    v_add_f32 v101, v101, v75
    v_add_f32 v101, v101, v76
    v_add_f32 v101, v101, v77
    v_add_f32 v101, v101, v78
    v_add_f32 v101, v101, v79
    s_nop 0
    s_nop 0
    v_add_f32_dpp v100, v100, v100 row_shr:1 row_mask:0xf bank_mask:0xf bound_ctrl:0
    v_add_f32_dpp v101, v101, v101 row_shr:1 row_mask:0xf bank_mask:0xf bound_ctrl:0
    s_nop 0
    v_add_f32_dpp v100, v100, v100 row_shr:2 row_mask:0xf bank_mask:0xf bound_ctrl:0
    v_add_f32_dpp v101, v101, v101 row_shr:2 row_mask:0xf bank_mask:0xf bound_ctrl:0
    s_nop 0
    v_add_f32_dpp v100, v100, v100 row_shr:4 row_mask:0xf bank_mask:0xf bound_ctrl:0
    v_add_f32_dpp v101, v101, v101 row_shr:4 row_mask:0xf bank_mask:0xf bound_ctrl:0
    s_nop 0
    v_add_f32_dpp v100, v100, v100 row_shr:8 row_mask:0xf bank_mask:0xf bound_ctrl:0
    v_add_f32_dpp v101, v101, v101 row_shr:8 row_mask:0xf bank_mask:0xf bound_ctrl:0
    s_nop 0
    v_add_f32_dpp v100, v100, v100 row_bcast:15 row_mask:0xa bank_mask:0xf
    v_add_f32_dpp v101, v101, v101 row_bcast:15 row_mask:0xa bank_mask:0xf
    s_nop 0
    v_add_f32_dpp v100, v100, v100 row_bcast:31 row_mask:0xc bank_mask:0xf
    v_add_f32_dpp v101, v101, v101 row_bcast:31 row_mask:0xc bank_mask:0xf
    s_mov_b32 s18, 0x3b000000
    v_mul_f32 v100, s18, v100
    v_mul_f32 v101, s18, v101
    s_nop 0
    v_readlane_b32 s16, v100, 63
    v_readlane_b32 s17, v101, 63
    s_nop 1
    v_subrev_f32 v64, s16, v64
    v_subrev_f32 v72, s17, v72
    v_subrev_f32 v65, s16, v65
    v_subrev_f32 v73, s17, v73
    v_subrev_f32 v66, s16, v66
    v_subrev_f32 v74, s17, v74
    v_subrev_f32 v67, s16, v67
    v_subrev_f32 v75, s17, v75
    v_subrev_f32 v68, s16, v68
    v_subrev_f32 v76, s17, v76
    v_subrev_f32 v69, s16, v69
    v_subrev_f32 v77, s17, v77
    v_subrev_f32 v70, s16, v70
    v_subrev_f32 v78, s17, v78
    v_subrev_f32 v71, s16, v71
    v_subrev_f32 v79, s17, v79
    v_mul_f32 v102, v64, v64
    v_mul_f32 v103, v72, v72
    v_fmac_f32 v102, v65, v65
    v_fmac_f32 v103, v73, v73
    v_fmac_f32 v102, v66, v66
    v_fmac_f32 v103, v74, v74
    v_fmac_f32 v102, v67, v67
    v_fmac_f32 v103, v75, v75
    v_fmac_f32 v102, v68, v68
    v_fmac_f32 v103, v76, v76
    v_fmac_f32 v102, v69, v69
    v_fmac_f32 v103, v77, v77
    v_fmac_f32 v102, v70, v70
    v_fmac_f32 v103, v78, v78
    v_fmac_f32 v102, v71, v71
    v_fmac_f32 v103, v79, v79
    s_nop 0
    s_nop 0
    v_add_f32_dpp v102, v102, v102 row_shr:1 row_mask:0xf bank_mask:0xf bound_ctrl:0
    v_add_f32_dpp v103, v103, v103 row_shr:1 row_mask:0xf bank_mask:0xf bound_ctrl:0
    s_nop 0
    v_add_f32_dpp v102, v102, v102 row_shr:2 row_mask:0xf bank_mask:0xf bound_ctrl:0
    v_add_f32_dpp v103, v103, v103 row_shr:2 row_mask:0xf bank_mask:0xf bound_ctrl:0
    s_nop 0
    v_add_f32_dpp v102, v102, v102 row_shr:4 row_mask:0xf bank_mask:0xf bound_ctrl:0
    v_add_f32_dpp v103, v103, v103 row_shr:4 row_mask:0xf bank_mask:0xf bound_ctrl:0
    s_nop 0
    v_add_f32_dpp v102, v102, v102 row_shr:8 row_mask:0xf bank_mask:0xf bound_ctrl:0
    v_add_f32_dpp v103, v103, v103 row_shr:8 row_mask:0xf bank_mask:0xf bound_ctrl:0
    s_nop 0
    v_add_f32_dpp v102, v102, v102 row_bcast:15 row_mask:0xa bank_mask:0xf
    v_add_f32_dpp v103, v103, v103 row_bcast:15 row_mask:0xa bank_mask:0xf
    s_nop 0
    v_add_f32_dpp v102, v102, v102 row_bcast:31 row_mask:0xc bank_mask:0xf
    v_add_f32_dpp v103, v103, v103 row_bcast:31 row_mask:0xc bank_mask:0xf
    v_mov_b32 v104, 0x3727c5ac
    v_fma_f32 v102, v102, s18, v104
    v_fma_f32 v103, v103, s18, v104
    v_rsq_f32 v108, v102
    v_rsq_f32 v112, v103
    v_mov_b32 v110, v254
    v_mov_b32 v114, v254
    v_mov_b32 v111, v254
    v_mov_b32 v115, v254
    v_mul_f32 v109, v100, v108
    v_mul_f32 v113, v101, v112
    v_sub_f32 v109, 0, v109
    v_sub_f32 v113, 0, v113
    s_lshr_b32 s15, s26, 5
    s_lshl_b32 s15, s15, 12
    s_lshl_b32 s16, s21, 11
    s_add_u32 s15, s15, s16
    s_bfe_u32 s16, s26, 0x40001
    s_lshl_b32 s16, s16, 5
    s_add_u32 s15, s15, s16
    s_and_b32 s16, s26, 1
    s_lshl_b32 s16, s16, 1
    s_add_u32 s16, s16, s20
    s_lshl_b32 s16, s16, 9
    s_add_u32 s15, s15, s16
    s_add_u32 s15, s15, 0x420000
    s_mov_b32 exec_lo, 0
    s_mov_b32 exec_hi, 0x80000000
    buffer_store_dwordx4 v[108:111], v5, s[40:43], s15 offen sc1
    buffer_store_dwordx4 v[112:115], v5, s[40:43], s15 offen offset:16 sc1
    s_mov_b64 exec, -1
    s_waitcnt vmcnt(2)
    s_barrier
    s_cmp_lg_u32 s3, 4
    s_cbranch_scc1 L_nopost3
    s_mov_b64 exec, 1
    s_mov_b32 s31, 0x430000
    buffer_store_dword v254, v253, s[40:43], s31 offen sc1
    s_mov_b64 exec, -1
L_nopost3:
    s_cmp_lg_u32 s3, 4
    s_cbranch_scc1 L_h_np1
    s_lshl_b32 s16, s4, 12
    s_add_u32 s16, s16, 0x430000
    v_add_u32 v7, s16, v17
    s_mov_b32 exec_hi, 0
    s_mov_b32 s30, 0x100000
L_poll4:
    buffer_load_dword v8, v7, s[40:43], 0 offen sc1
    s_waitcnt vmcnt(0)
    v_cmp_ne_u32 vcc, s9, v8
    s_sub_u32 s30, s30, 1
    s_cbranch_scc1 L_pollx4
    s_and_b64 exec, exec, vcc
    s_cbranch_execnz L_poll4
L_pollx4:
    s_mov_b64 exec, -1
L_h_np1:
    s_barrier
    v_lshlrev_b32 v9, 4, v3
    v_lshlrev_b32 v10, 3, v3
    v_add_u32 v10, 141056, v10
    s_add_u32 s16, s5, 0
    s_and_b32 s16, s16, 7
    s_lshl_b32 s16, s16, 11
    v_add_u32 v100, s16, v10
    s_add_u32 s16, s5, 1
    s_and_b32 s16, s16, 7
    s_lshl_b32 s16, s16, 11
    v_add_u32 v101, s16, v10
    s_add_u32 s16, s5, 2
    s_and_b32 s16, s16, 7
    s_lshl_b32 s16, s16, 11
    v_add_u32 v102, s16, v10
    s_add_u32 s16, s5, 3
    s_and_b32 s16, s16, 7
    s_lshl_b32 s16, s16, 11
    v_add_u32 v103, s16, v10
    s_add_u32 s16, s5, 4
    s_and_b32 s16, s16, 7
    s_lshl_b32 s16, s16, 11
    v_add_u32 v104, s16, v10
    s_add_u32 s16, s5, 5
    s_and_b32 s16, s16, 7
    s_lshl_b32 s16, s16, 11
    v_add_u32 v105, s16, v10
    s_add_u32 s16, s5, 6
    s_and_b32 s16, s16, 7
    s_lshl_b32 s16, s16, 11
    v_add_u32 v106, s16, v10
    s_add_u32 s16, s5, 7
    s_and_b32 s16, s16, 7
    s_lshl_b32 s16, s16, 11
    v_add_u32 v107, s16, v10
    s_add_u32 s16, s5, 0
    s_and_b32 s16, s16, 7
    s_lshl_b32 s16, s16, 12
    s_add_u32 s16, s16, 0x420000
    buffer_load_dwordx4 v[64:67], v9, s[40:43], s16 offen sc1
    s_add_u32 s16, s5, 1
    s_and_b32 s16, s16, 7
    s_lshl_b32 s16, s16, 12
    s_add_u32 s16, s16, 0x420000
    buffer_load_dwordx4 v[68:71], v9, s[40:43], s16 offen sc1
    s_add_u32 s16, s5, 2
    s_and_b32 s16, s16, 7
    s_lshl_b32 s16, s16, 12
    s_add_u32 s16, s16, 0x420000
    buffer_load_dwordx4 v[72:75], v9, s[40:43], s16 offen sc1
    s_add_u32 s16, s5, 3
    s_and_b32 s16, s16, 7
    s_lshl_b32 s16, s16, 12
    s_add_u32 s16, s16, 0x420000
    buffer_load_dwordx4 v[76:79], v9, s[40:43], s16 offen sc1
    s_add_u32 s16, s5, 4
    s_and_b32 s16, s16, 7
    s_lshl_b32 s16, s16, 12
    s_add_u32 s16, s16, 0x420000
    buffer_load_dwordx4 v[80:83], v9, s[40:43], s16 offen sc1
    s_add_u32 s16, s5, 5
    s_and_b32 s16, s16, 7
    s_lshl_b32 s16, s16, 12
    s_add_u32 s16, s16, 0x420000
    buffer_load_dwordx4 v[84:87], v9, s[40:43], s16 offen sc1
    s_add_u32 s16, s5, 6
    s_and_b32 s16, s16, 7
    s_lshl_b32 s16, s16, 12
    s_add_u32 s16, s16, 0x420000
    buffer_load_dwordx4 v[88:91], v9, s[40:43], s16 offen sc1
    s_add_u32 s16, s5, 7
    s_and_b32 s16, s16, 7
    s_lshl_b32 s16, s16, 12
    s_add_u32 s16, s16, 0x420000
    buffer_load_dwordx4 v[92:95], v9, s[40:43], s16 offen sc1
    s_barrier
    s_cmp_eq_u32 s7, 15
    s_cbranch_scc1 L_h_now0
    s_add_u32 s15, s8, 0
    s_and_b32 s15, s15, 7
    s_mul_i32 s15, s15, 176128
    s_add_u32 s15, s15, s22
    s_add_u32 m0, s23, 0
    s_nop 0
    buffer_load_dwordx4 v14, s[60:63], s15 offen lds
    buffer_load_dwordx4 v15, s[60:63], s15 offen offset:1024 lds
    buffer_load_dwordx4 v16, s[60:63], s15 offen offset:2048 lds
    s_add_u32 s15, s8, 0
    s_and_b32 s15, s15, 7
    s_mul_i32 s15, s15, 176128
    s_add_u32 s15, s15, s22
    s_add_u32 m0, s23, 12320
    s_nop 0
    buffer_load_dwordx4 v14, s[64:67], s15 offen lds
    buffer_load_dwordx4 v15, s[64:67], s15 offen offset:1024 lds
    buffer_load_dwordx4 v16, s[64:67], s15 offen offset:2048 lds
    s_waitcnt vmcnt(6)
    s_branch L_stg0
L_h_now0:
    s_waitcnt vmcnt(0)
L_stg0:
    s_setprio 3
    s_mov_b32 s30, 0x100000
L_stg:
    v_xor_b32 v50, s9, v66
    v_xor_b32 v51, s9, v70
    v_or_b32 v50, v50, v51
    v_xor_b32 v51, s9, v74
    v_or_b32 v50, v50, v51
    v_xor_b32 v51, s9, v78
    v_or_b32 v50, v50, v51
    v_xor_b32 v51, s9, v82
    v_or_b32 v50, v50, v51
    v_xor_b32 v51, s9, v86
    v_or_b32 v50, v50, v51
    v_xor_b32 v51, s9, v90
    v_or_b32 v50, v50, v51
    v_xor_b32 v51, s9, v94
    v_or_b32 v50, v50, v51
    v_cmp_ne_u32 vcc, 0, v50
    s_cbranch_vccz L_stgx
    s_sub_u32 s30, s30, 1
    s_cbranch_scc1 L_stgx
    s_add_u32 s16, s5, 0
    s_and_b32 s16, s16, 7
    s_lshl_b32 s16, s16, 12
    s_add_u32 s16, s16, 0x420000
    buffer_load_dwordx4 v[64:67], v9, s[40:43], s16 offen sc1
    s_add_u32 s16, s5, 1
    s_and_b32 s16, s16, 7
    s_lshl_b32 s16, s16, 12
    s_add_u32 s16, s16, 0x420000
    buffer_load_dwordx4 v[68:71], v9, s[40:43], s16 offen sc1
    s_add_u32 s16, s5, 2
    s_and_b32 s16, s16, 7
    s_lshl_b32 s16, s16, 12
    s_add_u32 s16, s16, 0x420000
    buffer_load_dwordx4 v[72:75], v9, s[40:43], s16 offen sc1
    s_add_u32 s16, s5, 3
    s_and_b32 s16, s16, 7
    s_lshl_b32 s16, s16, 12
    s_add_u32 s16, s16, 0x420000
    buffer_load_dwordx4 v[76:79], v9, s[40:43], s16 offen sc1
    s_add_u32 s16, s5, 4
    s_and_b32 s16, s16, 7
    s_lshl_b32 s16, s16, 12
    s_add_u32 s16, s16, 0x420000
    buffer_load_dwordx4 v[80:83], v9, s[40:43], s16 offen sc1
    s_add_u32 s16, s5, 5
    s_and_b32 s16, s16, 7
    s_lshl_b32 s16, s16, 12
    s_add_u32 s16, s16, 0x420000
    buffer_load_dwordx4 v[84:87], v9, s[40:43], s16 offen sc1
    s_add_u32 s16, s5, 6
    s_and_b32 s16, s16, 7
    s_lshl_b32 s16, s16, 12
    s_add_u32 s16, s16, 0x420000
    buffer_load_dwordx4 v[88:91], v9, s[40:43], s16 offen sc1
    s_add_u32 s16, s5, 7
    s_and_b32 s16, s16, 7
    s_lshl_b32 s16, s16, 12
    s_add_u32 s16, s16, 0x420000
    buffer_load_dwordx4 v[92:95], v9, s[40:43], s16 offen sc1
    s_waitcnt vmcnt(0)
    s_branch L_stg
L_stgx:
    ds_write_b64 v100, v[64:65]
    ds_write_b64 v101, v[68:69]
    ds_write_b64 v102, v[72:73]
    ds_write_b64 v103, v[76:77]
    ds_write_b64 v104, v[80:81]
    ds_write_b64 v105, v[84:85]
    ds_write_b64 v106, v[88:89]
    ds_write_b64 v107, v[92:93]
    s_lshl_b32 s15, s11, 2
    s_add_u32 s15, s15, 163792
    v_mov_b32 v50, s15
    v_mov_b32 v51, 1
    ds_write_b32 v50, v51
    s_setprio 0
    s_lshr_b32 s15, s5, 2
    s_lshl_b32 s15, s15, 2
    s_add_u32 s15, s15, s11
    s_mul_i32 s15, s15, 44032
    s_lshl_b32 s16, s28, 7
    s_add_u32 s15, s15, s16
    v_lshlrev_b32 v21, 10, v2
    s_mov_b32 exec_hi, 0x7ff
    buffer_load_dword v250, v21, s[68:71], s15 offen
    s_mov_b64 exec, -1
    s_cmp_eq_u32 s7, 15
    s_cbranch_scc1 L_h_now
    s_add_u32 s15, s8, 1
    s_and_b32 s15, s15, 7
    s_mul_i32 s15, s15, 176128
    s_add_u32 s15, s15, s22
    s_add_u32 m0, s23, 24640
    s_nop 0
    buffer_load_dwordx4 v14, s[60:63], s15 offen lds
    buffer_load_dwordx4 v15, s[60:63], s15 offen offset:1024 lds
    buffer_load_dwordx4 v16, s[60:63], s15 offen offset:2048 lds
    s_add_u32 s15, s8, 1
    s_and_b32 s15, s15, 7
    s_mul_i32 s15, s15, 176128
    s_add_u32 s15, s15, s22
    s_add_u32 m0, s23, 36960
    s_nop 0
    buffer_load_dwordx4 v14, s[64:67], s15 offen lds
    buffer_load_dwordx4 v15, s[64:67], s15 offen offset:1024 lds
    buffer_load_dwordx4 v16, s[64:67], s15 offen offset:2048 lds
    s_add_u32 s15, s8, 2
    s_and_b32 s15, s15, 7
    s_mul_i32 s15, s15, 176128
    s_add_u32 s15, s15, s22
    s_add_u32 m0, s23, 49280
    s_nop 0
    buffer_load_dwordx4 v14, s[60:63], s15 offen lds
    buffer_load_dwordx4 v15, s[60:63], s15 offen offset:1024 lds
    buffer_load_dwordx4 v16, s[60:63], s15 offen offset:2048 lds
    s_add_u32 s15, s8, 2
    s_and_b32 s15, s15, 7
    s_mul_i32 s15, s15, 176128
    s_add_u32 s15, s15, s22
    s_add_u32 m0, s23, 61600
    s_nop 0
    buffer_load_dwordx4 v14, s[64:67], s15 offen lds
    buffer_load_dwordx4 v15, s[64:67], s15 offen offset:1024 lds
    buffer_load_dwordx4 v16, s[64:67], s15 offen offset:2048 lds
L_h_now:
    v_and_b32 v20, 15, v2
    v_lshrrev_b32 v21, 4, v2
    v_lshrrev_b32 v22, 2, v20
    v_and_b32 v23, 3, v20
    v_lshrrev_b32 v24, 5, v2
    v_and_b32 v25, 1, v21
    v_lshl_add_u32 v26, v24, 3, v22
    v_lshlrev_b32 v27, 8, v26
    v_lshl_add_u32 v27, v25, 5, v27
    v_lshl_add_u32 v27, v23, 3, v27
    v_xor_b32 v17, s11, v22
    v_lshl_add_u32 v17, v17, 6, v27
    v_add_u32 v17, 98560, v17
    v_add_u32 v18, 16384, v17
    v_add_u32 v19, 32768, v17
    v_lshrrev_b32 v7, 3, v2
    v_lshlrev_b32 v7, 5, v7
    v_and_b32 v8, 7, v2
    v_add_u32 v7, v7, v8
    s_lshl_b32 s16, s11, 3
    v_add_u32 v7, s16, v7
    v_lshlrev_b32 v7, 7, v7
    s_lshl_b32 s16, s4, 15
    s_add_u32 s16, s16, 0x4d0000
    v_add_u32 v7, s16, v7
    s_lshl_b32 s26, s6, 17
    s_lshl_b32 s19, s11, 12
    s_add_u32 s26, s26, s19
    s_add_u32 s26, s26, 0x510000
    v_mov_b32 v20, 0
    v_mov_b32 v21, 0
    v_mov_b32 v22, 0
    v_mov_b32 v23, 0
    s_mov_b32 s27, 0x3f803f80
    s_lshl_b32 s16, s77, 9
    s_add_u32 s16, s16, 0x440000
    v_lshlrev_b32 v34, 7, v2
    v_add_u32 v34, s16, v34
    s_lshl_b32 s16, s9, 6
    s_add_u32 s16, s16, 30
    v_and_b32 v35, 2, v2
    v_add_u32 v35, s16, v35
    s_mov_b32 s29, 0
    v_mov_b32 v118, 1
    v_lshlrev_b32 v119, 10, v2
    s_lshl_b32 s16, s4, 0
    s_and_b32 s15, s5, 0
    s_add_u32 s16, s16, s15
    s_lshl_b32 s16, s16, 7
    s_add_u32 s16, s16, 0x4d0000
    v_add_u32 v119, s16, v119
    v_lshlrev_b32 v120, 7, v2
    s_and_b32 s16, s2, 15
    s_lshl_b32 s16, s16, 10
    s_add_u32 s16, s16, 0x4d0000
    v_add_u32 v120, s16, v120
    s_lshl_b32 s25, s9, 6
    s_add_u32 s25, s25, 32
    s_waitcnt vmcnt(13)
    s_barrier
    s_cmp_lg_u32 s3, 4
    s_cbranch_scc1 L_noadd
    s_mov_b32 exec_lo, 0xffff
    s_mov_b32 exec_hi, 0
    buffer_atomic_add v118, v119, s[40:43], 0 offen sc1
    s_mov_b64 exec, -1
L_noadd:
    s_cmp_eq_u32 s7, 15
    s_cbranch_scc1 L_now2
    s_add_u32 s15, s8, 3
    s_and_b32 s15, s15, 7
    s_mul_i32 s15, s15, 176128
    s_add_u32 s15, s15, s22
    s_add_u32 m0, s23, 73920
    s_nop 0
    buffer_load_dwordx4 v14, s[60:63], s15 offen lds
    buffer_load_dwordx4 v15, s[60:63], s15 offen offset:1024 lds
    buffer_load_dwordx4 v16, s[60:63], s15 offen offset:2048 lds
    s_add_u32 s15, s8, 3
    s_and_b32 s15, s15, 7
    s_mul_i32 s15, s15, 176128
    s_add_u32 s15, s15, s22
    s_add_u32 m0, s23, 86240
    s_nop 0
    buffer_load_dwordx4 v14, s[64:67], s15 offen lds
    buffer_load_dwordx4 v15, s[64:67], s15 offen offset:1024 lds
    buffer_load_dwordx4 v16, s[64:67], s15 offen offset:2048 lds
    s_add_u32 s15, s24, 0x110000
    buffer_load_dwordx4 v[234:237], v12, s[68:71], s15 offen
    s_add_u32 s15, s15, 8192
    buffer_load_dwordx4 v[238:241], v12, s[68:71], s15 offen
    s_cmp_ge_u32 s11, 3
    s_mov_b32 s16, 0x11c000
    s_cselect_b32 s15, 0xfffc4000, s16
    s_add_u32 s15, s15, s24
    buffer_load_dwordx4 v[242:245], v12, s[68:71], s15 offen
    s_add_u32 s15, s15, 8192
    buffer_load_dwordx4 v[246:249], v12, s[68:71], s15 offen
L_now2:
    s_cmp_lg_u32 s3, 4
    s_cbranch_scc1 L_nopoll2
    s_mov_b32 exec_lo, 0xff
    s_mov_b32 exec_hi, 0
    s_mov_b32 s30, 0x100000
L_poll5:
    v_mov_b32 v8, 0
    buffer_atomic_add v8, v120, s[40:43], 0 offen sc0 sc1
    s_waitcnt vmcnt(0)
    v_cmp_ne_u32 vcc, s25, v8
    s_sub_u32 s30, s30, 1
    s_cbranch_scc1 L_pollx5
    s_and_b64 exec, exec, vcc
    s_cbranch_execnz L_poll5
L_pollx5:
    s_mov_b64 exec, -1
L_nopoll2:
    s_barrier
    s_cmp_eq_u32 s7, 15
    s_cbranch_scc1 L_h_idle
    s_add_u32 s15, s8, 0
    s_and_b32 s15, s15, 7
    s_lshl_b32 s15, s15, 14
    s_add_u32 s15, s15, s26
    s_add_u32 m0, s19, 98560
    s_nop 0
    buffer_load_dwordx4 v11, s[40:43], s15 offen sc1 lds
    buffer_load_dwordx4 v11, s[40:43], s15 offen offset:1024 sc1 lds
    buffer_load_dwordx4 v11, s[40:43], s15 offen offset:2048 sc1 lds
    buffer_load_dwordx4 v11, s[40:43], s15 offen offset:3072 sc1 lds
    s_add_u32 s15, s8, 1
    s_and_b32 s15, s15, 7
    s_lshl_b32 s15, s15, 14
    s_add_u32 s15, s15, s26
    s_add_u32 m0, s19, 114944
    s_nop 0
    buffer_load_dwordx4 v11, s[40:43], s15 offen sc1 lds
    buffer_load_dwordx4 v11, s[40:43], s15 offen offset:1024 sc1 lds
    buffer_load_dwordx4 v11, s[40:43], s15 offen offset:2048 sc1 lds
    buffer_load_dwordx4 v11, s[40:43], s15 offen offset:3072 sc1 lds
    s_add_u32 s15, s8, 2
    s_and_b32 s15, s15, 7
    s_lshl_b32 s15, s15, 14
    s_add_u32 s15, s15, s26
    s_add_u32 m0, s19, 131328
    s_nop 0
    buffer_load_dwordx4 v11, s[40:43], s15 offen sc1 lds
    buffer_load_dwordx4 v11, s[40:43], s15 offen offset:1024 sc1 lds
    buffer_load_dwordx4 v11, s[40:43], s15 offen offset:2048 sc1 lds
    buffer_load_dwordx4 v11, s[40:43], s15 offen offset:3072 sc1 lds
    s_waitcnt vmcnt(8)
    s_barrier
    s_cmp_ge_u32 s11, 3
    s_mov_b32 s16, 0x120000
    s_cselect_b32 s15, 0xfffc8000, s16
    s_add_u32 s15, s15, s24
    buffer_load_dwordx4 v[122:125], v12, s[68:71], s15 offen
    s_add_u32 s15, s15, 8192
    buffer_load_dwordx4 v[126:129], v12, s[68:71], s15 offen
    s_cmp_ge_u32 s11, 2
    s_mov_b32 s16, 0x12c000
    s_cselect_b32 s15, 0xfffd4000, s16
    s_add_u32 s15, s15, s24
    buffer_load_dwordx4 v[130:133], v12, s[68:71], s15 offen
    s_add_u32 s15, s15, 8192
    buffer_load_dwordx4 v[134:137], v12, s[68:71], s15 offen
    s_add_u32 s15, s24, 0x28000
    buffer_load_dwordx4 v[138:141], v12, s[68:71], s15 offen
    s_add_u32 s15, s15, 8192
    buffer_load_dwordx4 v[142:145], v12, s[68:71], s15 offen
    s_add_u32 s15, s24, 0x34000
    buffer_load_dwordx4 v[146:149], v12, s[68:71], s15 offen
    s_add_u32 s15, s15, 8192
    buffer_load_dwordx4 v[150:153], v12, s[68:71], s15 offen
    s_add_u32 s15, s24, 0x88000
    buffer_load_dwordx4 v[154:157], v12, s[68:71], s15 offen
    s_add_u32 s15, s15, 8192
    buffer_load_dwordx4 v[158:161], v12, s[68:71], s15 offen
    s_add_u32 s15, s24, 0x94000
    buffer_load_dwordx4 v[162:165], v12, s[68:71], s15 offen
    s_add_u32 s15, s15, 8192
    buffer_load_dwordx4 v[166:169], v12, s[68:71], s15 offen
    s_waitcnt vmcnt(16)
    s_barrier
    s_add_u32 s15, s8, 3
    s_and_b32 s15, s15, 7
    s_lshl_b32 s15, s15, 14
    s_add_u32 s15, s15, s26
    s_add_u32 m0, s19, 98560
    s_nop 0
    buffer_load_dwordx4 v11, s[40:43], s15 offen sc1 lds
    buffer_load_dwordx4 v11, s[40:43], s15 offen offset:1024 sc1 lds
    buffer_load_dwordx4 v11, s[40:43], s15 offen offset:2048 sc1 lds
    buffer_load_dwordx4 v11, s[40:43], s15 offen offset:3072 sc1 lds
    s_add_u32 s15, s8, 4
    s_and_b32 s15, s15, 7
    s_mul_i32 s15, s15, 176128
    s_add_u32 s15, s15, s22
    s_add_u32 m0, s23, 0
    s_nop 0
    buffer_load_dwordx4 v14, s[60:63], s15 offen lds
    buffer_load_dwordx4 v15, s[60:63], s15 offen offset:1024 lds
    buffer_load_dwordx4 v16, s[60:63], s15 offen offset:2048 lds
    s_add_u32 s15, s8, 4
    s_and_b32 s15, s15, 7
    s_mul_i32 s15, s15, 176128
    s_add_u32 s15, s15, s22
    s_add_u32 m0, s23, 12320
    s_nop 0
    buffer_load_dwordx4 v14, s[64:67], s15 offen lds
    buffer_load_dwordx4 v15, s[64:67], s15 offen offset:1024 lds
    buffer_load_dwordx4 v16, s[64:67], s15 offen offset:2048 lds
    s_waitcnt vmcnt(22)
    s_barrier
    s_add_u32 s15, s8, 4
    s_and_b32 s15, s15, 7
    s_lshl_b32 s15, s15, 14
    s_add_u32 s15, s15, s26
    s_add_u32 m0, s19, 114944
    s_nop 0
    buffer_load_dwordx4 v11, s[40:43], s15 offen sc1 lds
    buffer_load_dwordx4 v11, s[40:43], s15 offen offset:1024 sc1 lds
    buffer_load_dwordx4 v11, s[40:43], s15 offen offset:2048 sc1 lds
    buffer_load_dwordx4 v11, s[40:43], s15 offen offset:3072 sc1 lds
    s_add_u32 s15, s8, 5
    s_and_b32 s15, s15, 7
    s_mul_i32 s15, s15, 176128
    s_add_u32 s15, s15, s22
    s_add_u32 m0, s23, 24640
    s_nop 0
    buffer_load_dwordx4 v14, s[60:63], s15 offen lds
    buffer_load_dwordx4 v15, s[60:63], s15 offen offset:1024 lds
    buffer_load_dwordx4 v16, s[60:63], s15 offen offset:2048 lds
    s_add_u32 s15, s24, 0xb0000
    buffer_load_dwordx4 v[218:221], v12, s[68:71], s15 offen
    s_add_u32 s15, s15, 8192
    buffer_load_dwordx4 v[222:225], v12, s[68:71], s15 offen
    s_add_u32 s15, s24, 0xbc000
    buffer_load_dwordx4 v[226:229], v12, s[68:71], s15 offen
    s_add_u32 s15, s15, 8192
    buffer_load_dwordx4 v[230:233], v12, s[68:71], s15 offen
    s_waitcnt vmcnt(17)
    s_barrier
    s_add_u32 s15, s8, 5
    s_and_b32 s15, s15, 7
    s_lshl_b32 s15, s15, 14
    s_add_u32 s15, s15, s26
    s_add_u32 m0, s19, 131328
    s_nop 0
    buffer_load_dwordx4 v11, s[40:43], s15 offen sc1 lds
    buffer_load_dwordx4 v11, s[40:43], s15 offen offset:1024 sc1 lds
    buffer_load_dwordx4 v11, s[40:43], s15 offen offset:2048 sc1 lds
    buffer_load_dwordx4 v11, s[40:43], s15 offen offset:3072 sc1 lds
    s_add_u32 s15, s8, 5
    s_and_b32 s15, s15, 7
    s_mul_i32 s15, s15, 176128
    s_add_u32 s15, s15, s22
    s_add_u32 m0, s23, 36960
    s_nop 0
    buffer_load_dwordx4 v14, s[64:67], s15 offen lds
    buffer_load_dwordx4 v15, s[64:67], s15 offen offset:1024 lds
    buffer_load_dwordx4 v16, s[64:67], s15 offen offset:2048 lds
    s_add_u32 s15, s8, 6
    s_and_b32 s15, s15, 7
    s_mul_i32 s15, s15, 176128
    s_add_u32 s15, s15, s22
    s_add_u32 m0, s23, 49280
    s_nop 0
    buffer_load_dwordx4 v14, s[60:63], s15 offen lds
    buffer_load_dwordx4 v15, s[60:63], s15 offen offset:1024 lds
    buffer_load_dwordx4 v16, s[60:63], s15 offen offset:2048 lds
    s_waitcnt vmcnt(17)
    s_barrier
    s_add_u32 s15, s8, 6
    s_and_b32 s15, s15, 7
    s_lshl_b32 s15, s15, 14
    s_add_u32 s15, s15, s26
    s_add_u32 m0, s19, 98560
    s_nop 0
    buffer_load_dwordx4 v11, s[40:43], s15 offen sc1 lds
    buffer_load_dwordx4 v11, s[40:43], s15 offen offset:1024 sc1 lds
    buffer_load_dwordx4 v11, s[40:43], s15 offen offset:2048 sc1 lds
    buffer_load_dwordx4 v11, s[40:43], s15 offen offset:3072 sc1 lds
    s_add_u32 s15, s8, 6
    s_and_b32 s15, s15, 7
    s_mul_i32 s15, s15, 176128
    s_add_u32 s15, s15, s22
    s_add_u32 m0, s23, 61600
    s_nop 0
    buffer_load_dwordx4 v14, s[64:67], s15 offen lds
    buffer_load_dwordx4 v15, s[64:67], s15 offen offset:1024 lds
    buffer_load_dwordx4 v16, s[64:67], s15 offen offset:2048 lds
    s_add_u32 s15, s8, 7
    s_and_b32 s15, s15, 7
    s_mul_i32 s15, s15, 176128
    s_add_u32 s15, s15, s22
    s_add_u32 m0, s23, 73920
    s_nop 0
    buffer_load_dwordx4 v14, s[60:63], s15 offen lds
    buffer_load_dwordx4 v15, s[60:63], s15 offen offset:1024 lds
    buffer_load_dwordx4 v16, s[60:63], s15 offen offset:2048 lds
    s_waitcnt vmcnt(13)
    s_barrier
    s_add_u32 s15, s8, 7
    s_and_b32 s15, s15, 7
    s_lshl_b32 s15, s15, 14
    s_add_u32 s15, s15, s26
    s_add_u32 m0, s19, 114944
    s_nop 0
    buffer_load_dwordx4 v11, s[40:43], s15 offen sc1 lds
    buffer_load_dwordx4 v11, s[40:43], s15 offen offset:1024 sc1 lds
    buffer_load_dwordx4 v11, s[40:43], s15 offen offset:2048 sc1 lds
    buffer_load_dwordx4 v11, s[40:43], s15 offen offset:3072 sc1 lds
    s_add_u32 s15, s8, 7
    s_and_b32 s15, s15, 7
    s_mul_i32 s15, s15, 176128
    s_add_u32 s15, s15, s22
    s_add_u32 m0, s23, 86240
    s_nop 0
    buffer_load_dwordx4 v14, s[64:67], s15 offen lds
    buffer_load_dwordx4 v15, s[64:67], s15 offen offset:1024 lds
    buffer_load_dwordx4 v16, s[64:67], s15 offen offset:2048 lds
    s_add_u32 m0, s19, 0
    s_add_u32 s15, s24, 0x0
    s_add_u32 s16, s15, 0x0
    buffer_load_dwordx4 v12, s[68:71], s16 offen offset:0 lds
    s_add_u32 s16, s15, 0x1c00
    buffer_load_dwordx4 v12, s[68:71], s16 offen offset:1024 lds
    s_add_u32 s15, s24, 0xc000
    s_add_u32 s16, s15, 0xfffff800
    buffer_load_dwordx4 v12, s[68:71], s16 offen offset:2048 lds
    s_add_u32 s16, s15, 0x1400
    buffer_load_dwordx4 v12, s[68:71], s16 offen offset:3072 lds
    s_mul_i32 s15, s7, 3072
    s_lshl_b32 s16, s11, 10
    s_add_u32 s15, s15, s16
    s_add_u32 s15, s15, 0x450000
    s_lshl_b32 s17, s6, 11
    s_add_u32 s17, s17, 0x448000
    s_cmp_eq_u32 s11, 3
    s_cselect_b32 s15, s17, s15
    s_add_u32 m0, s16, 147712
    s_nop 0
    buffer_load_dwordx4 v11, s[40:43], s15 offen sc1 lds
    s_mov_b32 m0, 150784
    s_nop 0
    buffer_load_dwordx4 v11, s[40:43], s17 offen offset:1024 sc1 lds
    s_waitcnt vmcnt(16)
    s_barrier
    s_add_u32 m0, s19, 16384
    s_add_u32 s15, s24, 0x60000
    s_add_u32 s16, s15, 0x0
    buffer_load_dwordx4 v12, s[68:71], s16 offen offset:0 lds
    s_add_u32 s16, s15, 0x1c00
    buffer_load_dwordx4 v12, s[68:71], s16 offen offset:1024 lds
    s_add_u32 s15, s24, 0x6c000
    s_add_u32 s16, s15, 0xfffff800
    buffer_load_dwordx4 v12, s[68:71], s16 offen offset:2048 lds
    s_add_u32 s16, s15, 0x1400
    buffer_load_dwordx4 v12, s[68:71], s16 offen offset:3072 lds
    s_waitcnt vmcnt(4)
    s_barrier
    s_add_u32 m0, s19, 32768
    s_add_u32 s15, s24, 0xc0000
    s_add_u32 s16, s15, 0x0
    buffer_load_dwordx4 v12, s[68:71], s16 offen offset:0 lds
    s_add_u32 s16, s15, 0x1c00
    buffer_load_dwordx4 v12, s[68:71], s16 offen offset:1024 lds
    s_add_u32 s15, s24, 0xcc000
    s_add_u32 s16, s15, 0xfffff800
    buffer_load_dwordx4 v12, s[68:71], s16 offen offset:2048 lds
    s_add_u32 s16, s15, 0x1400
    buffer_load_dwordx4 v12, s[68:71], s16 offen offset:3072 lds
    s_add_u32 s15, s24, 0xe8000
    buffer_load_dwordx4 v[170:173], v12, s[68:71], s15 offen
    s_add_u32 s15, s15, 8192
    buffer_load_dwordx4 v[174:177], v12, s[68:71], s15 offen
    s_add_u32 s15, s24, 0xf4000
    buffer_load_dwordx4 v[178:181], v12, s[68:71], s15 offen
    s_add_u32 s15, s15, 8192
    buffer_load_dwordx4 v[182:185], v12, s[68:71], s15 offen
    s_cmp_ge_u32 s11, 1
    s_mov_b32 s16, 0x148000
    s_cselect_b32 s15, 0xffff0000, s16
    s_add_u32 s15, s15, s24
    buffer_load_dwordx4 v[186:189], v12, s[68:71], s15 offen
    s_add_u32 s15, s15, 8192
    buffer_load_dwordx4 v[190:193], v12, s[68:71], s15 offen
    s_cmp_ge_u32 s11, 1
    s_mov_b32 s16, 0x154000
    s_cselect_b32 s15, 0xffffc000, s16
    s_add_u32 s15, s15, s24
    buffer_load_dwordx4 v[194:197], v12, s[68:71], s15 offen
    s_add_u32 s15, s15, 8192
    buffer_load_dwordx4 v[198:201], v12, s[68:71], s15 offen
    s_add_u32 s15, s24, 0x50000
    buffer_load_dwordx4 v[202:205], v12, s[68:71], s15 offen
    s_add_u32 s15, s15, 8192
    buffer_load_dwordx4 v[206:209], v12, s[68:71], s15 offen
    s_add_u32 s15, s24, 0x5c000
    buffer_load_dwordx4 v[210:213], v12, s[68:71], s15 offen
    s_add_u32 s15, s15, 8192
    buffer_load_dwordx4 v[214:217], v12, s[68:71], s15 offen
    v_add_u32 v30, s19, v11
    v_add_u32 v31, 0x10000, v30
    v_add_u32 v32, 0x20000, v30
    s_barrier
    s_setprio 3
    s_waitcnt vmcnt(0)
    s_cmp_lg_u32 s3, 4
    s_cbranch_scc1 L_pi6
    s_mov_b64 exec, 7
    v_mov_b32 v36, 0
    buffer_atomic_add v36, v34, s[40:43], 0 offen sc0 sc1
    s_mov_b64 exec, -1
L_pi6:
    ds_write_b128 v30, v[122:125] offset:49152
    ds_write_b128 v30, v[126:129] offset:50176
    ds_write_b128 v30, v[130:133] offset:51200
    ds_write_b128 v30, v[134:137] offset:52224
    ds_write_b128 v31, v[138:141] offset:0
    ds_write_b128 v31, v[142:145] offset:1024
    ds_write_b128 v31, v[146:149] offset:2048
    ds_write_b128 v31, v[150:153] offset:3072
    ds_write_b128 v31, v[154:157] offset:16384
    ds_write_b128 v31, v[158:161] offset:17408
    ds_write_b128 v31, v[162:165] offset:18432
    ds_write_b128 v31, v[166:169] offset:19456
    ds_write_b128 v31, v[170:173] offset:32768
    ds_write_b128 v31, v[174:177] offset:33792
    ds_write_b128 v31, v[178:181] offset:34816
    ds_write_b128 v31, v[182:185] offset:35840
    s_cmp_lg_u32 s3, 4
    s_cbranch_scc1 L_pt7
    s_mov_b64 exec, 7
    s_waitcnt vmcnt(0)
    v_cmp_eq_u32 vcc, v35, v36
    s_mov_b64 exec, -1
    s_mov_b32 s29, vcc_lo
L_pt7:
    s_cmp_lg_u32 s3, 4
    s_cbranch_scc1 L_p3x8
    s_mov_b32 s30, 0x100000
    s_mov_b64 exec, 7
L_p38:
    s_bitcmp1_b32 s29, 0
    s_cbranch_scc1 L_p3y8
    v_mov_b32 v36, 0
    buffer_atomic_add v36, v34, s[40:43], 0 offen sc0 sc1
    s_waitcnt vmcnt(0)
    v_cmp_eq_u32 vcc, v35, v36
    s_sub_u32 s30, s30, 1
    s_cbranch_scc1 L_p3y8
    s_mov_b32 s29, vcc_lo
    s_branch L_p38
L_p3y8:
    s_mov_b64 exec, -1
L_p3x8:
    s_waitcnt lgkmcnt(0)
    s_barrier
    ds_write_b128 v31, v[186:189] offset:49152
    ds_write_b128 v31, v[190:193] offset:50176
    ds_write_b128 v31, v[194:197] offset:51200
    ds_write_b128 v31, v[198:201] offset:52224
    ds_write_b128 v32, v[202:205] offset:0
    ds_write_b128 v32, v[206:209] offset:1024
    ds_write_b128 v32, v[210:213] offset:2048
    ds_write_b128 v32, v[214:217] offset:3072
    ds_write_b128 v32, v[218:221] offset:16384
    ds_write_b128 v32, v[222:225] offset:17408
    ds_write_b128 v32, v[226:229] offset:18432
    ds_write_b128 v32, v[230:233] offset:19456
    ds_write_b128 v30, v[234:237] offset:0
    ds_write_b128 v30, v[238:241] offset:1024
    ds_write_b128 v30, v[242:245] offset:2048
    ds_write_b128 v30, v[246:249] offset:3072
    s_cmp_lg_u32 s3, 4
    s_cbranch_scc1 L_p3x9
    s_mov_b32 s30, 0x100000
    s_mov_b64 exec, 7
L_p39:
    s_bitcmp1_b32 s29, 1
    s_cbranch_scc1 L_p3y9
    v_mov_b32 v36, 0
    buffer_atomic_add v36, v34, s[40:43], 0 offen sc0 sc1
    s_waitcnt vmcnt(0)
    v_cmp_eq_u32 vcc, v35, v36
    s_sub_u32 s30, s30, 1
    s_cbranch_scc1 L_p3y9
    s_mov_b32 s29, vcc_lo
    s_branch L_p39
L_p3y9:
    s_mov_b64 exec, -1
L_p3x9:
    s_waitcnt vmcnt(0) lgkmcnt(0)
    s_barrier
    s_branch L_h_q2
L_h_idle:
    s_add_u32 s15, s8, 0
    s_and_b32 s15, s15, 7
    s_lshl_b32 s15, s15, 14
    s_add_u32 s15, s15, s26
    s_add_u32 m0, s19, 0
    s_nop 0
    buffer_load_dwordx4 v11, s[40:43], s15 offen sc1 lds
    buffer_load_dwordx4 v11, s[40:43], s15 offen offset:1024 sc1 lds
    buffer_load_dwordx4 v11, s[40:43], s15 offen offset:2048 sc1 lds
    buffer_load_dwordx4 v11, s[40:43], s15 offen offset:3072 sc1 lds
    s_add_u32 s15, s8, 1
    s_and_b32 s15, s15, 7
    s_lshl_b32 s15, s15, 14
    s_add_u32 s15, s15, s26
    s_add_u32 m0, s19, 16384
    s_nop 0
    buffer_load_dwordx4 v11, s[40:43], s15 offen sc1 lds
    buffer_load_dwordx4 v11, s[40:43], s15 offen offset:1024 sc1 lds
    buffer_load_dwordx4 v11, s[40:43], s15 offen offset:2048 sc1 lds
    buffer_load_dwordx4 v11, s[40:43], s15 offen offset:3072 sc1 lds
    s_add_u32 s15, s8, 2
    s_and_b32 s15, s15, 7
    s_lshl_b32 s15, s15, 14
    s_add_u32 s15, s15, s26
    s_add_u32 m0, s19, 32768
    s_nop 0
    buffer_load_dwordx4 v11, s[40:43], s15 offen sc1 lds
    buffer_load_dwordx4 v11, s[40:43], s15 offen offset:1024 sc1 lds
    buffer_load_dwordx4 v11, s[40:43], s15 offen offset:2048 sc1 lds
    buffer_load_dwordx4 v11, s[40:43], s15 offen offset:3072 sc1 lds
    s_add_u32 s15, s8, 3
    s_and_b32 s15, s15, 7
    s_lshl_b32 s15, s15, 14
    s_add_u32 s15, s15, s26
    s_add_u32 m0, s19, 49152
    s_nop 0
    buffer_load_dwordx4 v11, s[40:43], s15 offen sc1 lds
    buffer_load_dwordx4 v11, s[40:43], s15 offen offset:1024 sc1 lds
    buffer_load_dwordx4 v11, s[40:43], s15 offen offset:2048 sc1 lds
    buffer_load_dwordx4 v11, s[40:43], s15 offen offset:3072 sc1 lds
    s_add_u32 s15, s8, 4
    s_and_b32 s15, s15, 7
    s_lshl_b32 s15, s15, 14
    s_add_u32 s15, s15, s26
    s_add_u32 m0, s19, 65536
    s_nop 0
    buffer_load_dwordx4 v11, s[40:43], s15 offen sc1 lds
    buffer_load_dwordx4 v11, s[40:43], s15 offen offset:1024 sc1 lds
    buffer_load_dwordx4 v11, s[40:43], s15 offen offset:2048 sc1 lds
    buffer_load_dwordx4 v11, s[40:43], s15 offen offset:3072 sc1 lds
    s_add_u32 s15, s8, 5
    s_and_b32 s15, s15, 7
    s_lshl_b32 s15, s15, 14
    s_add_u32 s15, s15, s26
    s_add_u32 m0, s19, 81920
    s_nop 0
    buffer_load_dwordx4 v11, s[40:43], s15 offen sc1 lds
    buffer_load_dwordx4 v11, s[40:43], s15 offen offset:1024 sc1 lds
    buffer_load_dwordx4 v11, s[40:43], s15 offen offset:2048 sc1 lds
    buffer_load_dwordx4 v11, s[40:43], s15 offen offset:3072 sc1 lds
    s_add_u32 s15, s8, 6
    s_and_b32 s15, s15, 7
    s_lshl_b32 s15, s15, 14
    s_add_u32 s15, s15, s26
    s_add_u32 m0, s19, 98304
    s_nop 0
    buffer_load_dwordx4 v11, s[40:43], s15 offen sc1 lds
    buffer_load_dwordx4 v11, s[40:43], s15 offen offset:1024 sc1 lds
    buffer_load_dwordx4 v11, s[40:43], s15 offen offset:2048 sc1 lds
    buffer_load_dwordx4 v11, s[40:43], s15 offen offset:3072 sc1 lds
    s_add_u32 s15, s8, 7
    s_and_b32 s15, s15, 7
    s_lshl_b32 s15, s15, 14
    s_add_u32 s15, s15, s26
    s_add_u32 m0, s19, 114688
    s_nop 0
    buffer_load_dwordx4 v11, s[40:43], s15 offen sc1 lds
    buffer_load_dwordx4 v11, s[40:43], s15 offen offset:1024 sc1 lds
    buffer_load_dwordx4 v11, s[40:43], s15 offen offset:2048 sc1 lds
    buffer_load_dwordx4 v11, s[40:43], s15 offen offset:3072 sc1 lds
    v_subrev_u32 v17, 98560, v17
    v_mov_b32 v28, s27
    v_mov_b32 v29, s27
    v_mov_b32 v30, s27
    v_mov_b32 v31, s27
    s_waitcnt vmcnt(16)
    s_barrier
    ds_read_b64_tr_b16 v[100:101], v17 offset:0
    ds_read_b64_tr_b16 v[102:103], v17 offset:1024
    ds_read_b64_tr_b16 v[104:105], v17 offset:4096
    ds_read_b64_tr_b16 v[106:107], v17 offset:5120
    ds_read_b64_tr_b16 v[108:109], v17 offset:8192
    ds_read_b64_tr_b16 v[110:111], v17 offset:9216
    ds_read_b64_tr_b16 v[112:113], v17 offset:12288
    ds_read_b64_tr_b16 v[114:115], v17 offset:13312
    ds_read_b64_tr_b16 v[116:117], v17 offset:16384
    ds_read_b64_tr_b16 v[118:119], v17 offset:17408
    ds_read_b64_tr_b16 v[120:121], v17 offset:20480
    ds_read_b64_tr_b16 v[122:123], v17 offset:21504
    s_waitcnt lgkmcnt(10)
    v_mfma_f32_32x32x16_bf16 v[64:79], v[28:31], v[100:103], 0
    ds_read_b64_tr_b16 v[124:125], v17 offset:24576
    ds_read_b64_tr_b16 v[126:127], v17 offset:25600
    s_waitcnt lgkmcnt(10)
    v_mfma_f32_32x32x16_bf16 v[64:79], v[28:31], v[104:107], v[64:79]
    ds_read_b64_tr_b16 v[128:129], v17 offset:28672
    ds_read_b64_tr_b16 v[130:131], v17 offset:29696
    s_waitcnt lgkmcnt(10)
    v_mfma_f32_32x32x16_bf16 v[64:79], v[28:31], v[108:111], v[64:79]
    ds_read_b64_tr_b16 v[132:133], v17 offset:32768
    ds_read_b64_tr_b16 v[134:135], v17 offset:33792
    s_waitcnt lgkmcnt(10)
    v_mfma_f32_32x32x16_bf16 v[64:79], v[28:31], v[112:115], v[64:79]
    ds_read_b64_tr_b16 v[136:137], v17 offset:36864
    ds_read_b64_tr_b16 v[138:139], v17 offset:37888
    s_waitcnt lgkmcnt(10)
    v_mfma_f32_32x32x16_bf16 v[64:79], v[28:31], v[116:119], v[64:79]
    ds_read_b64_tr_b16 v[140:141], v17 offset:40960
    ds_read_b64_tr_b16 v[142:143], v17 offset:41984
    s_waitcnt lgkmcnt(10)
    v_mfma_f32_32x32x16_bf16 v[64:79], v[28:31], v[120:123], v[64:79]
    ds_read_b64_tr_b16 v[144:145], v17 offset:45056
    ds_read_b64_tr_b16 v[146:147], v17 offset:46080
    s_waitcnt lgkmcnt(10)
    v_mfma_f32_32x32x16_bf16 v[64:79], v[28:31], v[124:127], v[64:79]
    ds_read_b64_tr_b16 v[148:149], v17 offset:49152
    ds_read_b64_tr_b16 v[150:151], v17 offset:50176
    s_waitcnt lgkmcnt(10)
    v_mfma_f32_32x32x16_bf16 v[64:79], v[28:31], v[128:131], v[64:79]
    ds_read_b64_tr_b16 v[152:153], v17 offset:53248
    ds_read_b64_tr_b16 v[154:155], v17 offset:54272
    s_waitcnt lgkmcnt(10)
    v_mfma_f32_32x32x16_bf16 v[64:79], v[28:31], v[132:135], v[64:79]
    ds_read_b64_tr_b16 v[156:157], v17 offset:57344
    ds_read_b64_tr_b16 v[158:159], v17 offset:58368
    s_waitcnt lgkmcnt(10)
    v_mfma_f32_32x32x16_bf16 v[64:79], v[28:31], v[136:139], v[64:79]
    ds_read_b64_tr_b16 v[160:161], v17 offset:61440
    ds_read_b64_tr_b16 v[162:163], v17 offset:62464
    s_waitcnt lgkmcnt(10)
    v_mfma_f32_32x32x16_bf16 v[64:79], v[28:31], v[140:143], v[64:79]
    s_waitcnt lgkmcnt(8)
    v_mfma_f32_32x32x16_bf16 v[64:79], v[28:31], v[144:147], v[64:79]
    s_waitcnt lgkmcnt(6)
    v_mfma_f32_32x32x16_bf16 v[64:79], v[28:31], v[148:151], v[64:79]
    s_waitcnt lgkmcnt(4)
    v_mfma_f32_32x32x16_bf16 v[64:79], v[28:31], v[152:155], v[64:79]
    s_waitcnt lgkmcnt(2)
    v_mfma_f32_32x32x16_bf16 v[64:79], v[28:31], v[156:159], v[64:79]
    s_waitcnt lgkmcnt(0)
    v_mfma_f32_32x32x16_bf16 v[64:79], v[28:31], v[160:163], v[64:79]
    v_add_u32 v17, 0x10000, v17
    s_waitcnt vmcnt(0)
    s_barrier
    ds_read_b64_tr_b16 v[164:165], v17 offset:0
    ds_read_b64_tr_b16 v[166:167], v17 offset:1024
    ds_read_b64_tr_b16 v[168:169], v17 offset:4096
    ds_read_b64_tr_b16 v[170:171], v17 offset:5120
    ds_read_b64_tr_b16 v[172:173], v17 offset:8192
    ds_read_b64_tr_b16 v[174:175], v17 offset:9216
    ds_read_b64_tr_b16 v[176:177], v17 offset:12288
    ds_read_b64_tr_b16 v[178:179], v17 offset:13312
    ds_read_b64_tr_b16 v[180:181], v17 offset:16384
    ds_read_b64_tr_b16 v[182:183], v17 offset:17408
    ds_read_b64_tr_b16 v[184:185], v17 offset:20480
    ds_read_b64_tr_b16 v[186:187], v17 offset:21504
    s_waitcnt lgkmcnt(10)
    v_mfma_f32_32x32x16_bf16 v[64:79], v[28:31], v[164:167], v[64:79]
    ds_read_b64_tr_b16 v[188:189], v17 offset:24576
    ds_read_b64_tr_b16 v[190:191], v17 offset:25600
    s_waitcnt lgkmcnt(10)
    v_mfma_f32_32x32x16_bf16 v[64:79], v[28:31], v[168:171], v[64:79]
    ds_read_b64_tr_b16 v[192:193], v17 offset:28672
    ds_read_b64_tr_b16 v[194:195], v17 offset:29696
    s_waitcnt lgkmcnt(10)
    v_mfma_f32_32x32x16_bf16 v[64:79], v[28:31], v[172:175], v[64:79]
    ds_read_b64_tr_b16 v[196:197], v17 offset:32768
    ds_read_b64_tr_b16 v[198:199], v17 offset:33792
    s_waitcnt lgkmcnt(10)
    v_mfma_f32_32x32x16_bf16 v[64:79], v[28:31], v[176:179], v[64:79]
    ds_read_b64_tr_b16 v[200:201], v17 offset:36864
    ds_read_b64_tr_b16 v[202:203], v17 offset:37888
    s_waitcnt lgkmcnt(10)
    v_mfma_f32_32x32x16_bf16 v[64:79], v[28:31], v[180:183], v[64:79]
    ds_read_b64_tr_b16 v[204:205], v17 offset:40960
    ds_read_b64_tr_b16 v[206:207], v17 offset:41984
    s_waitcnt lgkmcnt(10)
    v_mfma_f32_32x32x16_bf16 v[64:79], v[28:31], v[184:187], v[64:79]
    ds_read_b64_tr_b16 v[208:209], v17 offset:45056
    ds_read_b64_tr_b16 v[210:211], v17 offset:46080
    s_waitcnt lgkmcnt(10)
    v_mfma_f32_32x32x16_bf16 v[64:79], v[28:31], v[188:191], v[64:79]
    ds_read_b64_tr_b16 v[212:213], v17 offset:49152
    ds_read_b64_tr_b16 v[214:215], v17 offset:50176
    s_waitcnt lgkmcnt(10)
    v_mfma_f32_32x32x16_bf16 v[64:79], v[28:31], v[192:195], v[64:79]
    ds_read_b64_tr_b16 v[216:217], v17 offset:53248
    ds_read_b64_tr_b16 v[218:219], v17 offset:54272
    s_waitcnt lgkmcnt(10)
    v_mfma_f32_32x32x16_bf16 v[64:79], v[28:31], v[196:199], v[64:79]
    ds_read_b64_tr_b16 v[220:221], v17 offset:57344
    ds_read_b64_tr_b16 v[222:223], v17 offset:58368
    s_waitcnt lgkmcnt(10)
    v_mfma_f32_32x32x16_bf16 v[64:79], v[28:31], v[200:203], v[64:79]
    ds_read_b64_tr_b16 v[224:225], v17 offset:61440
    ds_read_b64_tr_b16 v[226:227], v17 offset:62464
    s_waitcnt lgkmcnt(10)
    v_mfma_f32_32x32x16_bf16 v[64:79], v[28:31], v[204:207], v[64:79]
    s_waitcnt lgkmcnt(8)
    v_mfma_f32_32x32x16_bf16 v[64:79], v[28:31], v[208:211], v[64:79]
    s_waitcnt lgkmcnt(6)
    v_mfma_f32_32x32x16_bf16 v[64:79], v[28:31], v[212:215], v[64:79]
    s_waitcnt lgkmcnt(4)
    v_mfma_f32_32x32x16_bf16 v[64:79], v[28:31], v[216:219], v[64:79]
    s_waitcnt lgkmcnt(2)
    v_mfma_f32_32x32x16_bf16 v[64:79], v[28:31], v[220:223], v[64:79]
    s_waitcnt lgkmcnt(0)
    v_mfma_f32_32x32x16_bf16 v[64:79], v[28:31], v[224:227], v[64:79]
    v_add_u32 v17, 0x10000, v17
    v_mfma_f32_32x32x16_bf16 v[80:95], v[100:103], v[100:103], 0
    v_mfma_f32_32x32x16_bf16 v[80:95], v[104:107], v[104:107], v[80:95]
    v_mfma_f32_32x32x16_bf16 v[80:95], v[108:111], v[108:111], v[80:95]
    v_mfma_f32_32x32x16_bf16 v[80:95], v[112:115], v[112:115], v[80:95]
    s_nop 7
    v_mul_f32 v27, s18, v64
    v_sub_f32 v24, 0, v27
    v_cvt_pk_bf16_f32 v20, v24, v24
    v_and_b32 v25, s14, v20
    v_sub_f32 v25, v24, v25
    v_mov_b32 v22, 0
    v_cvt_pk_bf16_f32 v21, v25, v22
    v_mov_b32 v23, v254
    s_lshl_b32 s15, s6, 11
    s_lshl_b32 s16, s11, 9
    s_add_u32 s15, s15, s16
    s_add_u32 s15, s15, 0x448000
    s_mov_b32 exec_hi, 0
    buffer_store_dwordx4 v[20:23], v11, s[40:43], s15 offen sc1
    s_mov_b64 exec, -1
    s_barrier
    v_mfma_f32_32x32x16_bf16 v[80:95], v[116:119], v[116:119], v[80:95]
    s_add_u32 m0, s19, 0
    s_add_u32 s15, s24, 0x0
    s_add_u32 s16, s15, 0x0
    buffer_load_dwordx4 v12, s[68:71], s16 offen offset:0 lds
    v_mfma_f32_32x32x16_bf16 v[80:95], v[120:123], v[120:123], v[80:95]
    s_add_u32 s16, s15, 0x1c00
    buffer_load_dwordx4 v12, s[68:71], s16 offen offset:1024 lds
    v_mfma_f32_32x32x16_bf16 v[80:95], v[124:127], v[124:127], v[80:95]
    s_add_u32 s15, s24, 0xc000
    s_add_u32 s16, s15, 0xfffff800
    buffer_load_dwordx4 v12, s[68:71], s16 offen offset:2048 lds
    v_mfma_f32_32x32x16_bf16 v[80:95], v[128:131], v[128:131], v[80:95]
    s_add_u32 s16, s15, 0x1400
    buffer_load_dwordx4 v12, s[68:71], s16 offen offset:3072 lds
    v_mfma_f32_32x32x16_bf16 v[80:95], v[132:135], v[132:135], v[80:95]
    s_add_u32 m0, s19, 16384
    s_add_u32 s15, s24, 0x60000
    s_add_u32 s16, s15, 0x0
    buffer_load_dwordx4 v12, s[68:71], s16 offen offset:0 lds
    v_mfma_f32_32x32x16_bf16 v[80:95], v[136:139], v[136:139], v[80:95]
    s_add_u32 s16, s15, 0x1c00
    buffer_load_dwordx4 v12, s[68:71], s16 offen offset:1024 lds
    v_mfma_f32_32x32x16_bf16 v[80:95], v[140:143], v[140:143], v[80:95]
    s_add_u32 s15, s24, 0x6c000
    s_add_u32 s16, s15, 0xfffff800
    buffer_load_dwordx4 v12, s[68:71], s16 offen offset:2048 lds
    v_mfma_f32_32x32x16_bf16 v[80:95], v[144:147], v[144:147], v[80:95]
    s_add_u32 s16, s15, 0x1400
    buffer_load_dwordx4 v12, s[68:71], s16 offen offset:3072 lds
    v_mfma_f32_32x32x16_bf16 v[80:95], v[148:151], v[148:151], v[80:95]
    s_add_u32 m0, s19, 32768
    s_add_u32 s15, s24, 0xc0000
    s_add_u32 s16, s15, 0x0
    buffer_load_dwordx4 v12, s[68:71], s16 offen offset:0 lds
    v_mfma_f32_32x32x16_bf16 v[80:95], v[152:155], v[152:155], v[80:95]
    s_add_u32 s16, s15, 0x1c00
    buffer_load_dwordx4 v12, s[68:71], s16 offen offset:1024 lds
    v_mfma_f32_32x32x16_bf16 v[80:95], v[156:159], v[156:159], v[80:95]
    s_add_u32 s15, s24, 0xcc000
    s_add_u32 s16, s15, 0xfffff800
    buffer_load_dwordx4 v12, s[68:71], s16 offen offset:2048 lds
    v_mfma_f32_32x32x16_bf16 v[80:95], v[160:163], v[160:163], v[80:95]
    s_add_u32 s16, s15, 0x1400
    buffer_load_dwordx4 v12, s[68:71], s16 offen offset:3072 lds
    v_mfma_f32_32x32x16_bf16 v[80:95], v[164:167], v[164:167], v[80:95]
    s_add_u32 m0, s19, 49152
    s_cmp_ge_u32 s11, 3
    s_mov_b32 s16, 0x120000
    s_cselect_b32 s15, 0xfffc8000, s16
    s_add_u32 s15, s15, s24
    s_add_u32 s16, s15, 0x0
    buffer_load_dwordx4 v12, s[68:71], s16 offen offset:0 lds
    v_mfma_f32_32x32x16_bf16 v[80:95], v[168:171], v[168:171], v[80:95]
    s_add_u32 s16, s15, 0x1c00
    buffer_load_dwordx4 v12, s[68:71], s16 offen offset:1024 lds
    v_mfma_f32_32x32x16_bf16 v[80:95], v[172:175], v[172:175], v[80:95]
    s_cmp_ge_u32 s11, 2
    s_mov_b32 s16, 0x12c000
    s_cselect_b32 s15, 0xfffd4000, s16
    s_add_u32 s15, s15, s24
    s_add_u32 s16, s15, 0xfffff800
    buffer_load_dwordx4 v12, s[68:71], s16 offen offset:2048 lds
    v_mfma_f32_32x32x16_bf16 v[80:95], v[176:179], v[176:179], v[80:95]
    s_add_u32 s16, s15, 0x1400
    buffer_load_dwordx4 v12, s[68:71], s16 offen offset:3072 lds
    v_mfma_f32_32x32x16_bf16 v[80:95], v[180:183], v[180:183], v[80:95]
    s_add_u32 m0, s19, 65536
    s_add_u32 s15, s24, 0x28000
    s_add_u32 s16, s15, 0x0
    buffer_load_dwordx4 v12, s[68:71], s16 offen offset:0 lds
    v_mfma_f32_32x32x16_bf16 v[80:95], v[184:187], v[184:187], v[80:95]
    s_add_u32 s16, s15, 0x1c00
    buffer_load_dwordx4 v12, s[68:71], s16 offen offset:1024 lds
    v_mfma_f32_32x32x16_bf16 v[80:95], v[188:191], v[188:191], v[80:95]
    s_add_u32 s15, s24, 0x34000
    s_add_u32 s16, s15, 0xfffff800
    buffer_load_dwordx4 v12, s[68:71], s16 offen offset:2048 lds
    v_mfma_f32_32x32x16_bf16 v[80:95], v[192:195], v[192:195], v[80:95]
    s_add_u32 s16, s15, 0x1400
    buffer_load_dwordx4 v12, s[68:71], s16 offen offset:3072 lds
    v_mfma_f32_32x32x16_bf16 v[80:95], v[196:199], v[196:199], v[80:95]
    s_add_u32 m0, s19, 81920
    s_add_u32 s15, s24, 0x88000
    s_add_u32 s16, s15, 0x0
    buffer_load_dwordx4 v12, s[68:71], s16 offen offset:0 lds
    v_mfma_f32_32x32x16_bf16 v[80:95], v[200:203], v[200:203], v[80:95]
    s_add_u32 s16, s15, 0x1c00
    buffer_load_dwordx4 v12, s[68:71], s16 offen offset:1024 lds
    v_mfma_f32_32x32x16_bf16 v[80:95], v[204:207], v[204:207], v[80:95]
    s_add_u32 s15, s24, 0x94000
    s_add_u32 s16, s15, 0xfffff800
    buffer_load_dwordx4 v12, s[68:71], s16 offen offset:2048 lds
    v_mfma_f32_32x32x16_bf16 v[80:95], v[208:211], v[208:211], v[80:95]
    s_add_u32 s16, s15, 0x1400
    buffer_load_dwordx4 v12, s[68:71], s16 offen offset:3072 lds
    v_mfma_f32_32x32x16_bf16 v[80:95], v[212:215], v[212:215], v[80:95]
    s_add_u32 m0, s19, 98304
    s_add_u32 s15, s24, 0xe8000
    s_add_u32 s16, s15, 0x0
    buffer_load_dwordx4 v12, s[68:71], s16 offen offset:0 lds
    v_mfma_f32_32x32x16_bf16 v[80:95], v[216:219], v[216:219], v[80:95]
    s_add_u32 s16, s15, 0x1c00
    buffer_load_dwordx4 v12, s[68:71], s16 offen offset:1024 lds
    v_mfma_f32_32x32x16_bf16 v[80:95], v[220:223], v[220:223], v[80:95]
    s_add_u32 s15, s24, 0xf4000
    s_add_u32 s16, s15, 0xfffff800
    buffer_load_dwordx4 v12, s[68:71], s16 offen offset:2048 lds
    v_mfma_f32_32x32x16_bf16 v[80:95], v[224:227], v[224:227], v[80:95]
    s_add_u32 s16, s15, 0x1400
    buffer_load_dwordx4 v12, s[68:71], s16 offen offset:3072 lds
    s_add_u32 m0, s19, 114688
    s_cmp_ge_u32 s11, 1
    s_mov_b32 s16, 0x148000
    s_cselect_b32 s15, 0xffff0000, s16
    s_add_u32 s15, s15, s24
    s_add_u32 s16, s15, 0x0
    buffer_load_dwordx4 v12, s[68:71], s16 offen offset:0 lds
    s_add_u32 s16, s15, 0x1c00
    buffer_load_dwordx4 v12, s[68:71], s16 offen offset:1024 lds
    s_cmp_ge_u32 s11, 1
    s_mov_b32 s16, 0x154000
    s_cselect_b32 s15, 0xffffc000, s16
    s_add_u32 s15, s15, s24
    s_add_u32 s16, s15, 0xfffff800
    buffer_load_dwordx4 v12, s[68:71], s16 offen offset:2048 lds
    s_add_u32 s16, s15, 0x1400
    buffer_load_dwordx4 v12, s[68:71], s16 offen offset:3072 lds
    s_add_u32 m0, s19, 131072
    s_add_u32 s15, s24, 0x50000
    s_add_u32 s16, s15, 0x0
    buffer_load_dwordx4 v12, s[68:71], s16 offen offset:0 lds
    s_add_u32 s16, s15, 0x1c00
    buffer_load_dwordx4 v12, s[68:71], s16 offen offset:1024 lds
    s_add_u32 s15, s24, 0x5c000
    s_add_u32 s16, s15, 0xfffff800
    buffer_load_dwordx4 v12, s[68:71], s16 offen offset:2048 lds
    s_add_u32 s16, s15, 0x1400
    buffer_load_dwordx4 v12, s[68:71], s16 offen offset:3072 lds
    s_add_u32 m0, s19, 147456
    s_add_u32 s15, s24, 0xb0000
    s_add_u32 s16, s15, 0x0
    buffer_load_dwordx4 v12, s[68:71], s16 offen offset:0 lds
    s_add_u32 s16, s15, 0x1c00
    buffer_load_dwordx4 v12, s[68:71], s16 offen offset:1024 lds
    s_add_u32 s15, s24, 0xbc000
    s_add_u32 s16, s15, 0xfffff800
    buffer_load_dwordx4 v12, s[68:71], s16 offen offset:2048 lds
    s_add_u32 s16, s15, 0x1400
    buffer_load_dwordx4 v12, s[68:71], s16 offen offset:3072 lds
    v_bfe_u32 v22, v2, 3, 2
    v_lshlrev_b32 v22, 2, v22
    v_and_b32 v23, 3, v2
    v_add_u32 v22, v22, v23
    v_bfe_u32 v23, v2, 2, 1
    v_lshrrev_b32 v24, 5, v2
    v_xor_b32 v23, v23, v24
    v_lshl_add_u32 v22, v23, 4, v22
    v_mov_b32 v21, 0
    s_nop 7
    v_cmp_eq_u32 vcc, 0, v22
    s_nop 1
    v_cndmask_b32 v21, v21, v80, vcc
    v_cmp_eq_u32 s[76:77], 1, v22
    s_nop 1
    v_cndmask_b32 v21, v21, v81, s[76:77]
    v_cmp_eq_u32 vcc, 2, v22
    s_nop 1
    v_cndmask_b32 v21, v21, v82, vcc
    v_cmp_eq_u32 s[76:77], 3, v22
    s_nop 1
    v_cndmask_b32 v21, v21, v83, s[76:77]
    v_cmp_eq_u32 vcc, 4, v22
    s_nop 1
    v_cndmask_b32 v21, v21, v84, vcc
    v_cmp_eq_u32 s[76:77], 5, v22
    s_nop 1
    v_cndmask_b32 v21, v21, v85, s[76:77]
    v_cmp_eq_u32 vcc, 6, v22
    s_nop 1
    v_cndmask_b32 v21, v21, v86, vcc
    v_cmp_eq_u32 s[76:77], 7, v22
    s_nop 1
    v_cndmask_b32 v21, v21, v87, s[76:77]
    v_cmp_eq_u32 vcc, 8, v22
    s_nop 1
    v_cndmask_b32 v21, v21, v88, vcc
    v_cmp_eq_u32 s[76:77], 9, v22
    s_nop 1
    v_cndmask_b32 v21, v21, v89, s[76:77]
    v_cmp_eq_u32 vcc, 10, v22
    s_nop 1
    v_cndmask_b32 v21, v21, v90, vcc
    v_cmp_eq_u32 s[76:77], 11, v22
    s_nop 1
    v_cndmask_b32 v21, v21, v91, s[76:77]
    v_cmp_eq_u32 vcc, 12, v22
    s_nop 1
    v_cndmask_b32 v21, v21, v92, vcc
    v_cmp_eq_u32 s[76:77], 13, v22
    s_nop 1
    v_cndmask_b32 v21, v21, v93, s[76:77]
    v_cmp_eq_u32 vcc, 14, v22
    s_nop 1
    v_cndmask_b32 v21, v21, v94, vcc
    v_cmp_eq_u32 s[76:77], 15, v22
    s_nop 1
    v_cndmask_b32 v21, v21, v95, s[76:77]
    v_mov_b32 v23, v21
    s_nop 1
    v_permlane32_swap_b32 v23, v21
    s_nop 1
    v_add_f32 v21, v21, v23
    v_mul_f32 v21, s18, v21
    v_fma_f32 v21, -v27, v27, v21
    v_max_f32 v21, 0, v21
    v_add_f32 v21, 0x3727c5ac, v21
    v_rcp_f32 v22, v21
    v_lshlrev_b32 v23, 2, v2
    s_lshl_b32 s15, s6, 9
    s_lshl_b32 s16, s11, 7
    s_add_u32 s15, s15, s16
    s_add_u32 s15, s15, 0x460000
    s_mov_b32 exec_hi, 0
    buffer_store_dword v22, v23, s[40:43], s15 offen sc1
    s_mov_b64 exec, -1
    s_waitcnt vmcnt(0)
    s_lshl_b32 s15, s6, 1
    s_add_u32 s15, s15, s20
    s_lshl_b32 s15, s15, 9
    s_add_u32 s15, s15, 0x440100
    v_mov_b32 v22, 1
    v_mov_b32 v23, s15
    s_mov_b64 exec, 1
    buffer_atomic_add v22, v23, s[40:43], 0 offen sc1
    s_mov_b64 exec, -1
    s_barrier
    s_barrier
    s_add_u32 m0, s19, 0
    s_add_u32 s15, s24, 0x110000
    s_add_u32 s16, s15, 0x0
    buffer_load_dwordx4 v12, s[68:71], s16 offen offset:0 lds
    s_add_u32 s16, s15, 0x1c00
    buffer_load_dwordx4 v12, s[68:71], s16 offen offset:1024 lds
    s_cmp_ge_u32 s11, 3
    s_mov_b32 s16, 0x11c000
    s_cselect_b32 s15, 0xfffc4000, s16
    s_add_u32 s15, s15, s24
    s_add_u32 s16, s15, 0xfffff800
    buffer_load_dwordx4 v12, s[68:71], s16 offen offset:2048 lds
    s_add_u32 s16, s15, 0x1400
    buffer_load_dwordx4 v12, s[68:71], s16 offen offset:3072 lds
    s_cmp_lg_u32 s3, 4
    s_cbranch_scc1 L_p3x10
    s_mov_b32 s30, 0x100000
    s_mov_b64 exec, 7
L_p310:
    s_bitcmp1_b32 s29, 0
    s_cbranch_scc1 L_p3y10
    v_mov_b32 v36, 0
    buffer_atomic_add v36, v34, s[40:43], 0 offen sc0 sc1
    s_waitcnt vmcnt(0)
    v_cmp_eq_u32 vcc, v35, v36
    s_sub_u32 s30, s30, 1
    s_cbranch_scc1 L_p3y10
    s_mov_b32 s29, vcc_lo
    s_branch L_p310
L_p3y10:
    s_mov_b64 exec, -1
L_p3x10:
    s_barrier
    s_cmp_lg_u32 s3, 4
    s_cbranch_scc1 L_p3x11
    s_mov_b32 s30, 0x100000
    s_mov_b64 exec, 7
L_p311:
    s_bitcmp1_b32 s29, 1
    s_cbranch_scc1 L_p3y11
    v_mov_b32 v36, 0
    buffer_atomic_add v36, v34, s[40:43], 0 offen sc0 sc1
    s_waitcnt vmcnt(0)
    v_cmp_eq_u32 vcc, v35, v36
    s_sub_u32 s30, s30, 1
    s_cbranch_scc1 L_p3y11
    s_mov_b32 s29, vcc_lo
    s_branch L_p311
L_p3y11:
    s_mov_b64 exec, -1
L_p3x11:
    s_barrier
L_h_q2:
    s_cmp_lg_u32 s3, 4
    s_cbranch_scc1 L_p3x12
    s_mov_b32 s30, 0x100000
    s_mov_b64 exec, 7
L_p312:
    s_bitcmp1_b32 s29, 2
    s_cbranch_scc1 L_p3y12
    v_mov_b32 v36, 0
    buffer_atomic_add v36, v34, s[40:43], 0 offen sc0 sc1
    s_waitcnt vmcnt(0)
    v_cmp_eq_u32 vcc, v35, v36
    s_sub_u32 s30, s30, 1
    s_cbranch_scc1 L_p3y12
    s_mov_b32 s29, vcc_lo
    s_branch L_p312
L_p3y12:
    s_mov_b64 exec, -1
L_p3x12:
    s_waitcnt vmcnt(0) lgkmcnt(0)
    s_barrier
    s_cmp_lg_u32 s2, 0
    s_cbranch_scc1 L_hend
    s_cmp_lg_u32 s3, 4
    s_cbranch_scc1 L_hend
    s_mov_b64 exec, 1
    buffer_store_dword v254, v255, s[40:43], 0 offen sc1
L_hend:
    s_endpgm
L_end:
    s_endpgm
.section .rodata,"a"
.p2align 6
.amdhsa_kernel sequential_preLN__ssm_conv_h3__glu_gated_reglu__prompt_kernel
  .amdhsa_next_free_vgpr 256
  .amdhsa_next_free_sgpr 102
  .amdhsa_accum_offset 256
  .amdhsa_group_segment_fixed_size 0
  .amdhsa_kernarg_size 104
  .amdhsa_user_sgpr_count 2
  .amdhsa_user_sgpr_kernarg_segment_ptr 1
  .amdhsa_system_sgpr_workgroup_id_x 1
  .amdhsa_float_denorm_mode_32 3
.end_amdhsa_kernel
```
